```python
import torch

def _softmax(x, axis=-1):
    return torch.softmax(x, dim=axis)
def _gelu(x):
    return torch.nn.functional.gelu(x, approximate="tanh")
def _silu(x):
    return torch.nn.functional.silu(x)
def _sigmoid(x):
    return torch.sigmoid(x)
def _layernorm(x, axis=-1, eps=1e-5):
    m = x.mean(dim=axis, keepdim=True)
    v = x.var(dim=axis, keepdim=True, unbiased=False)
    return (x - m) / torch.sqrt(v + eps)
def _scatter_add(tgt, idx, src, axis=0):
    return tgt.clone().index_add_(axis, idx, src)
def _segment_sum(src, seg, n):
    out = torch.zeros((n,) + src.shape[1:], dtype=src.dtype)
    return out.index_add_(0, seg, src)
def _pad(x, pw):
    flat = tuple(v for pair in reversed(pw) for v in pair)
    return torch.nn.functional.pad(x, flat)

kernel_name = 'recurrent_scan__ssm_conv_s4__moe_arch_mod__prompt'

def setup_inputs():

    _w = (lambda a: (lambda t: t.to(torch.bfloat16) if t.is_floating_point() else t)(torch.as_tensor(a)))
    def _A_setup():
        B, L, D, N = 1, 2048, 448, 256
        A_re = -(lambda _x: torch.exp(torch.as_tensor(_x)))((lambda *s: torch.randn(*s, dtype=torch.bfloat16) * 6.4)(D, N))
        A_im = torch.pi * (lambda *s: torch.randn(*s, dtype=torch.bfloat16) * 0.05)(D, N)
        B_re = (lambda *s: torch.randn(*s, dtype=torch.bfloat16) * 0.1)(D, N)
        B_im = (lambda *s: torch.randn(*s, dtype=torch.bfloat16) * 0.1)(D, N)
        C_re = (lambda *s: torch.randn(*s, dtype=torch.bfloat16) * 0.1)(D, N)
        C_im = (lambda *s: torch.randn(*s, dtype=torch.bfloat16) * 0.1)(D, N)
        log_dt = (lambda *s: torch.randn(*s, dtype=torch.bfloat16) * 0.05)(D) * 0.5 - 4.0
        Dskip = (lambda *s: torch.randn(*s, dtype=torch.bfloat16) * 0.05)(D)
        return {
            "u": _w((lambda *s: torch.randn(*s, dtype=torch.bfloat16) * 0.05)(B, L, D)),
            "A_re": _w(A_re),
            "A_im": _w(A_im),
            "B_re": _w(B_re),
            "B_im": _w(B_im),
            "C_re": _w(C_re),
            "C_im": _w(C_im),
            "log_dt": _w(log_dt),
            "Dskip": _w(Dskip),
        }
    _A_in = _A_setup()

    def _B_setup():
        B, S, D, F, C = 1, 2048, 448, 1792, 1
        return {
            "x": _w((lambda *s: torch.randn(*s, dtype=torch.bfloat16) * 0.05)(B, S, D)),
            "w_r": _w((lambda *s: torch.randn(*s, dtype=torch.bfloat16) * 6.4)(D)),
            "w_gate": _w((lambda *s: torch.randn(*s, dtype=torch.bfloat16) * 0.1)(D, F)),
            "w_up": _w((lambda *s: torch.randn(*s, dtype=torch.bfloat16) * 0.1)(D, F)),
            "w_down": _w((lambda *s: torch.randn(*s, dtype=torch.bfloat16) * 0.1)(F, D)),
        }
    _B_in = _B_setup()

    return {
        "A_u": _A_in["u"],
        "A_A_re": _A_in["A_re"],
        "A_A_im": _A_in["A_im"],
        "A_B_re": _A_in["B_re"],
        "A_B_im": _A_in["B_im"],
        "A_C_re": _A_in["C_re"],
        "A_C_im": _A_in["C_im"],
        "A_log_dt": _A_in["log_dt"],
        "A_Dskip": _A_in["Dskip"],
        "B_x": _B_in["x"],
        "B_w_r": _B_in["w_r"],
        "B_w_gate": _B_in["w_gate"],
        "B_w_up": _B_in["w_up"],
        "B_w_down": _B_in["w_down"],
    }

def reference(A_u, A_A_re, A_A_im, A_B_re, A_B_im, A_C_re, A_C_im, A_log_dt, A_Dskip, B_x, B_w_r, B_w_gate, B_w_up, B_w_down):
    def _A_ref(u, A_re, A_im, B_re, B_im, C_re, C_im, log_dt, Dskip):
        Bsz, L, D = u.shape
        dt = torch.exp(log_dt)[:, None]
        A = A_re + 1j * A_im
        Bc = B_re + 1j * B_im
        Cc = C_re + 1j * C_im
        logdA = dt * A
        dB = dt * Bc
        l = (lambda x, dt: x.to(dt))(torch.arange(L), A_re.dtype)
        P = torch.exp(logdA[:, :, None] * l[None, None, :])
        K = torch.einsum("dn,dnl,dn->dl", Cc, P, dB).real
        L2 = 2 * L
        Kp = _pad(K, ((0, 0), (0, L)))
        up = (lambda x, *d: x.permute(*d))(u, 0, 2, 1)
        up = _pad(up, ((0, 0), (0, 0), (0, L)))
        Kf = (lambda x, axes=(-2,-1): torch.fft.rfft2(x.float(), dim=axes))(Kp[:, None, :], axes=(-2, -1))
        Uf = (lambda x, axes=(-2,-1): torch.fft.rfft2(x.float(), dim=axes))(up[:, :, None, :], axes=(-2, -1))
        Yf = Uf * Kf[None, :, :, :]
        y = (lambda x, s, axes=(-2,-1): torch.fft.irfft2(x, s=s, dim=axes).to(torch.bfloat16))(Yf, (1, L2), axes=(-2, -1))[:, :, 0, :L]
        y = (lambda x, *d: x.permute(*d))(y, 0, 2, 1) + u * Dskip[None, None, :]
        return y

    def _B_ref(x, w_r, w_gate, w_up, w_down):
        B, S, D = x.shape
        C = 1
        r = x @ w_r
        idx = torch.argsort(-r, axis=-1)[:, :C]
        idx_e = (lambda x, n, axis: torch.repeat_interleave(x, n, dim=axis))(idx.reshape(B, C, 1), D, axis=2)
        x_sel = (lambda x, i, axis: torch.take_along_dim(x, i, dim=axis))(x, idx_e, axis=1)
        g = _silu(x_sel @ w_gate)
        u = x_sel @ w_up
        y = (g * u) @ w_down
        r_sel = _sigmoid((lambda x, i, axis: torch.take_along_dim(x, i, dim=axis))(r, idx, axis=1))
        y = y * r_sel.reshape(B, C, 1)
        b_off = (torch.arange(B) * S).reshape(B, 1)
        flat_idx = (idx + b_off).reshape(B * C)
        zero = (x * 0.0).reshape(B * S, D)
        upd = _scatter_add(zero, flat_idx, y.reshape(B * C, D), axis=0)
        return x + upd.reshape(B, S, D)

    x = A_u
    xn = _layernorm(x, axis=-1)
    s = _A_ref(xn, A_A_re, A_A_im, A_B_re, A_B_im, A_C_re, A_C_im, A_log_dt, A_Dskip)
    g = _silu(_B_ref(xn, B_w_r, B_w_gate, B_w_up, B_w_down))
    return x + s * g
```

```asm
; @launch grid=(256,1,1) block=(512,1,1) lds=155648
.amdgcn_target "amdgcn-amd-amdhsa--gfx950"
.text
.globl recurrent_scan__ssm_conv_s4__moe_arch_mod__prompt_kernel
.p2align 8
.type recurrent_scan__ssm_conv_s4__moe_arch_mod__prompt_kernel,@function
recurrent_scan__ssm_conv_s4__moe_arch_mod__prompt_kernel:
    s_load_dwordx16 s[16:31], s[0:1], 0
    s_load_dwordx16 s[32:47], s[0:1], 64
    s_load_dwordx2 s[48:49], s[0:1], 128
    v_lshrrev_b32 v4, 6, v0
    v_and_b32_e64 v1, 63, v0
    v_readfirstlane_b32 s3, v4
    s_cmp_lt_u32 s2, 224
    s_cbranch_scc1 L_pro0
    s_cmp_ge_u32 s2, 256
    s_cbranch_scc1 L_end
    s_cmp_lt_u32 s3, 4
    s_cbranch_scc1 L_pro0
    s_getpc_b64 s[12:13]
L_pc:
    v_and_b32 v16, 255, v0
    v_lshlrev_b32 v16, 7, v16
    v_min_u32 v16, L_codeend-L_pc-4, v16
    global_load_dword v2, v16, s[12:13]
    s_branch L_fha
L_pro0:
    s_and_b32 s8, s2, 7
    s_lshr_b32 s9, s2, 3
    s_mul_i32 s51, s8, 28
    s_add_u32 s51, s51, s9
    s_and_b32 s9, s9, 3
    s_and_b32 s10, s2, 0xe0
    s_lshl2_add_u32 s10, s8, s10
    s_add_u32 s50, s10, s9
    s_lshl3_add_u32 s7, s10, s9
    s_mov_b32 s54, 1835008
    s_mov_b32 s55, 0x20000
    s_movk_i32 s58, 896
    s_mov_b32 s59, s55
    s_and_b32 s9, s3, 6
    s_and_b32 s10, s3, 1
    s_lshl1_add_u32 s8, s51, s10
    s_lshl3_add_u32 s8, s8, s9
    s_lshl_b32 s8, s8, 6
    v_lshl_add_u32 v47, v1, 1, s8
    v_mov_b32 v48, 0
    v_mov_b32 v49, 0
    v_mov_b32 v50, 0
    v_mov_b32 v51, 0
    v_mov_b32 v52, 0
    v_mov_b32 v53, 0
    v_lshlrev_b32_e64 v18, 3, v1
    v_add_u32 v18, 155136, v18
    ds_write_b64 v18, v[48:49]
    v_and_b32 v88, 31, v1
    v_lshrrev_b32 v89, 5, v1
    v_bfrev_b32 v109, 1
    v_lshlrev_b32 v90, 4, v88
    v_lshlrev_b32_e64 v11, 4, v1
    s_mov_b32 s62, 0x1000000
    s_mov_b32 s63, s55
    s_lshl_b32 s11, s51, 2
    s_cmp_ge_u32 s3, 4
    s_cbranch_scc1 L_hp0
    v_cmp_gt_u32 vcc, 28, v88
    s_movk_i32 s12, 3584
    s_lshl3_add_u32 s4, s3, s7
    v_cndmask_b32 v8, v109, v90, vcc
    s_mul_i32 s5, s4, 896
    v_mad_u32_u24 v9, v89, s12, v8
    s_cmp_ge_u32 s2, 224
    s_waitcnt lgkmcnt(0)
    s_mov_b64 s[52:53], s[16:17]
    s_mov_b64 s[56:57], s[36:37]
    s_nop 0
    buffer_load_dwordx4 v[80:83], v9, s[52:55], s5 offen
    buffer_load_dwordx4 v[84:87], v9, s[52:55], s5 offen offset:448
    buffer_load_dwordx4 v[12:15], v8, s[56:59], 0 offen
    buffer_load_dwordx4 v[16:19], v8, s[56:59], 0 offen offset:448
    s_load_dwordx4 s[68:71], s[48:49], 0
    s_mov_b64 s[60:61], s[48:49]
    s_barrier
    s_cbranch_scc1 L_pro1b
    s_nop 0
    global_load_short_d16_hi v48, v47, s[18:19]
    global_load_short_d16_hi v49, v47, s[20:21]
    global_load_short_d16_hi v50, v47, s[22:23]
    global_load_short_d16_hi v51, v47, s[24:25]
    global_load_short_d16_hi v52, v47, s[26:27]
    global_load_short_d16_hi v53, v47, s[28:29]
    s_load_dword s100, s[30:31], s11
L_pro1b:
    s_branch L_pro2
L_hp0:
    s_mul_i32 s12, s50, 7168
    s_lshl_b32 s13, s3, 11
    s_add_u32 s12, s12, s13
    s_add_u32 s12, s12, 0x23e000
    s_lshl_b32 s13, s2, 10
    s_add_u32 s13, s13, 0x20fc00
    s_cmp_lt_u32 s2, 112
    s_cselect_b32 s13, s13, s62
    s_cmp_eq_u32 s3, 7
    s_cselect_b32 s13, s13, s12
    v_mov_b32 v20, -1
    v_mov_b32 v21, -1
    v_mov_b32 v22, -1
    v_mov_b32_e64 v23, -1
    s_cmp_ge_u32 s2, 224
    s_waitcnt lgkmcnt(0)
    s_mov_b64 s[60:61], s[48:49]
    s_cbranch_scc1 L_hp0b
    s_nop 0
    global_load_short_d16_hi v48, v47, s[18:19]
    global_load_short_d16_hi v49, v47, s[20:21]
    global_load_short_d16_hi v50, v47, s[22:23]
    global_load_short_d16_hi v51, v47, s[24:25]
    global_load_short_d16_hi v52, v47, s[26:27]
    global_load_short_d16_hi v53, v47, s[28:29]
    s_load_dword s100, s[30:31], s11
L_hp0b:
    buffer_store_dwordx4 v[20:23], v11, s[60:63], s12 offen sc1
    buffer_store_dwordx4 v[20:23], v11, s[60:63], s13 offen offset:1024 sc1
    s_load_dwordx4 s[68:71], s[48:49], 0
    s_mov_b64 s[52:53], s[16:17]
    s_barrier
    s_cbranch_scc1 L_fhb
L_pro2:
    s_mov_b64 s[56:57], s[32:33]
    v_lshlrev_b32 v29, 1, v0
    v_mov_b32 v32, 0
    buffer_load_short_d16_hi v32, v29, s[56:59], 0 offen
    v_mov_b32 v3, 0x40074007
    s_lshl_b32 s12, s3, 5
    s_add_u32 s10, s12, 155136
    v_mov_b32 v10, s10
    v_bfe_u32 v6, v1, 2, 2
    v_mul_u32_u24 v31, 960, v6
    v_and_b32_e64 v7, 3, v1
    v_lshl_add_u32 v31, v7, 3, v31
    v_lshrrev_b32_e64 v30, 4, v0
    v_lshl_add_u32 v31, v30, 5, v31
    v_add_u32 v31, 139520, v31
    s_lshr_b32 s12, s50, 2
    s_mul_i32 s13, s12, 28672
    s_and_b32 s14, s50, 3
    s_lshl4_add_u32 s13, s14, s13
    s_add_u32 s13, s13, 0x240000
    v_lshl_add_u32 v28, v0, 6, s13
    s_mul_i32 s34, s7, 896
    v_mov_b32 v35, v109
    s_mul_i32 s8, s3, 15232
    v_mul_u32_u24 v110, 272, v88
    v_lshl_add_u32 v110, v89, 4, v110
    v_add_u32_e64 v110, s8, v110
    s_mov_b32 s12, 0x202000
    v_lshrrev_b32 v111, v88, s12
    v_and_b32_e64 v111, 1, v111
    v_mul_u32_u24 v111, 272, v111
    v_sub_u32 v111, v110, v111
    s_and_b32 s6, s3, 1
    v_lshlrev_b32 v91, 2, v1
    v_mov_b32 v24, 0
    v_mov_b32_e64 v25, 0
    s_cmp_lt_u32 s3, 4
    s_cbranch_scc1 L_lset
    s_cmp_ge_u32 s2, 224
    s_cbranch_scc1 L_hpro_other
    s_and_b32 s12, s2, 0xf8
    s_and_b32 s13, s2, 7
    v_and_b32_e64 v12, 15, v1
    v_lshl_add_u32 v12, s12, 1, v12
    v_lshrrev_b32_e64 v13, 4, v1
    v_lshl_add_u32 v13, v13, 3, s13
    s_movk_i32 s15, 128
    s_cmp_eq_u32 s3, 6
    s_cselect_b32 s12, s15, 3584
    s_cselect_b32 s13, 57344, s15
    v_mul_u32_u24_e64 v12, s12, v12
    v_mad_u32_u24 v12, v13, s13, v12
    v_min_u32 v109, 1605628, v12
    s_cmp_eq_u32 s3, 6
    s_cselect_b64 s[46:47], s[42:43], s[38:39]
    s_cmp_eq_u32 s3, 5
    s_cselect_b64 s[46:47], s[40:41], s[46:47]
    s_bitcmp1_b32 48, s3
    s_cselect_b64 s[46:47], s[46:47], s[44:45]
    s_cselect_b64 vcc, -1, 0
    v_mov_b32 v12, s34
    v_cndmask_b32_e64 v12, v12, v109, vcc
    global_load_dword v2, v12, s[46:47]
    s_waitcnt lgkmcnt(0)
    s_add_u32 s68, s68, 1
    s_add_u32 s69, s69, 1
    s_add_u32 s70, s70, 1
    s_add_u32 s71, s71, 1
    s_mov_b32 m0, s8
    s_lshl_b32 s12, s100, 16
    s_and_b32 s13, s100, 0xffff0000
    s_bitcmp1_b32 s3, 0
    s_cselect_b32 s12, s13, s12
    v_mov_b32 v106, 0x3fb8aa3b
    v_mul_f32 v105, s12, v106
    v_exp_f32_e64 v105, v105
    v_mov_b32 v107, 0x3c00
    ds_write_addtid_b32 v107
    v_cvt_pk_bf16_f32 v105, 0, v105
    v_mul_f32 v106, v105, v106
    v_mul_f32_e64 v107, 0x3e22f983, v105
    s_setprio 1
    s_waitcnt vmcnt(4)
    s_waitcnt vmcnt(2)
    ds_write_b32 v10, v3 offset:20
    s_branch L_kgen
L_lset:
    s_lshl_b32 s9, s3, 2
    s_load_dword s101, s[48:49], s9
    v_cndmask_b32 v44, 0, -1.0, vcc
    v_mov_b32 v45, 448
    v_cndmask_b32_e64 v36, v45, v90, vcc
    s_mul_i32 s13, s3, 1920
    s_add_u32 s13, s13, 139520
    v_mul_u32_u24 v38, 960, v89
    v_add3_u32 v36, v36, v38, s13
    v_cndmask_b32 v37, v45, 0, vcc
    v_add_u32 v37, v37, v36
    s_lshl_b32 s12, s3, 3
    s_add_u32 s12, s12, 154880
    v_lshl_add_u32 v45, v89, 2, s12
    s_sub_u32 s4, 2047, s4
    v_lshlrev_b32 v46, 2, v89
    v_sub_u32 v46, s4, v46
    v_lshrrev_b32 v39, 3, v0
    v_lshlrev_b32 v39, 15, v39
    v_and_b32_e64 v8, 7, v1
    v_lshl_add_u32 v39, v8, 4, v39
    s_lshl_b32 s9, s50, 7
    s_add_u32 s9, s9, 0x50000
    v_add_u32 v92, 155136, v91
    v_lshlrev_b32 v93, 4, v89
    v_mov_b32 v94, 0xffff
    v_mov_b32 v98, 154880
    v_add_u32 v99, 139520, v11
    s_mul_i32 s10, s6, 15232
    s_add_u32 s10, s10, 60928
    v_add_u32 v113, s10, v91
    s_lshl_b32 s11, s6, 5
    s_add_u32 s11, s11, 155292
    v_mov_b32 v120, s11
    s_xor_b32 s11, s3, 2
    s_mul_i32 s10, s11, 15232
    v_add_u32 v114, s10, v91
    s_lshl_b32 s11, s11, 5
    s_add_u32 s11, s11, 155136
    v_mov_b32_e64 v117, s11
    s_mul_i32 s10, s6, 4160
    s_add_u32 s10, s10, 131200
    v_add_u32_e64 v115, s10, v11
    v_lshl_add_u32 v116, v89, 3, v90
    v_add_u32 v116, s10, v116
    v_and_b32 v5, 60, v91
    v_add_u32_e64 v5, s10, v5
    ds_write_b32 v5, v24
    v_lshlrev_b32 v5, 6, v89
    v_sub_u32 v4, v90, v5
    s_mul_i32 s12, s6, 4672
    s_add_u32 s12, s12, 121920
    v_add_u32 v4, s12, v4
    v_lshrrev_b32 v5, 4, v1
    v_lshl_add_u32 v5, v5, 2, v7
    v_sub_u32 v5, v5, v6
    s_add_u32 s12, s10, 32
    v_lshl_add_u32 v5, v5, 3, s12
    v_sub_u32 v6, 62, v1
    v_sub_u32 v7, 61, v1
    v_sub_u32 v8, 60, v1
    v_ashrrev_i32 v6, 31, v6
    v_ashrrev_i32 v7, 31, v7
    v_ashrrev_i32 v8, 31, v8
    s_lshl_b32 s12, s3, 10
    v_and_b32 v33, 0x30, v11
    v_lshl_add_u32 v33, v89, 6, v33
    v_bfe_u32 v34, v1, 2, 3
    v_lshl_add_u32 v33, v34, 1, v33
    v_add_u32_e64 v33, s12, v33
    v_mul_u32_u24 v35, 28672, v34
    v_and_b32 v34, 48, v11
    v_add_u32 v35, v35, v34
    v_lshl_or_b32 v35, v89, 31, v35
    v_add_u32_e64 v34, s12, v11
    s_lshl1_add_u32 s30, s51, s6
    s_lshl_b32 s30, s30, 6
    s_add_u32 s30, s30, 0x240000
    v_and_b32 v121, 1, v1
    v_sub_u32 v121, 0, v121
    s_mov_b32 s10, 0x3f803f80
    s_mov_b32 s11, 0x3f80
    s_mov_b32 s15, 0x3f800000
    s_brev_b32 s14, 1
    s_waitcnt lgkmcnt(0)
    s_add_u32 s68, s68, 1
    s_add_u32 s69, s69, 1
    s_add_u32 s70, s70, 1
    s_add_u32 s71, s71, 1
    s_add_u32 s101, s101, 1
    v_lshrrev_b32 v93, v93, s101
    v_and_b32_e64 v93, v94, v93
    v_lshl_or_b32 v93, v93, 16, v93
    s_cmp_lt_u32 s2, 224
    s_cbranch_scc1 L_w5
    s_waitcnt vmcnt(1)
    s_branch L_w6
L_w5:
    s_mov_b32 m0, s8
    s_lshl_b32 s12, s100, 16
    s_and_b32 s13, s100, 0xffff0000
    s_bitcmp1_b32 s3, 0
    s_cselect_b32 s12, s13, s12
    v_mov_b32 v106, 0x3fb8aa3b
    v_mul_f32 v105, s12, v106
    v_exp_f32_e64 v105, v105
    v_mov_b32 v107, 0x3c00
    ds_write_addtid_b32 v107
    v_cvt_pk_bf16_f32 v105, 0, v105
    v_mul_f32 v106, v105, v106
    v_mul_f32_e64 v107, 0x3e22f983, v105
L_w6:
    s_setprio 2
    s_mov_b32 s12, 0x20202020
    s_mov_b32 s13, s12
    s_add_u32 s4, s9, 1048576
    s_waitcnt vmcnt(9)
    v_dot2_f32_bf16 v40, v80, s10, 0
    v_dot2_f32_bf16 v41, v84, s10, 0
    v_dot2_f32_bf16 v40, v81, s10, v40
    v_dot2_f32_bf16 v41, v85, s10, v41
    v_dot2_f32_bf16 v40, v82, s10, v40
    v_dot2_f32_bf16 v41, v86, s10, v41
    v_dot2_f32_bf16 v40, v83, s10, v40
    v_dot2_f32_bf16 v41, v87, s10, v41
    ds_write_b128 v37, v[80:83] offset:7680
    ds_write_b128 v36, v[84:87] offset:8128
    s_nop 0
    v_add_f32_e64 v40, v40, v41
    s_nop 1
    v_add_f32_dpp v40, v40, v40 row_ror:8 row_mask:0xf bank_mask:0xf
    s_nop 1
    v_add_f32_dpp v40, v40, v40 row_ror:4 row_mask:0xf bank_mask:0xf
    s_nop 1
    v_add_f32_dpp v40, v40, v40 row_ror:2 row_mask:0xf bank_mask:0xf
    s_nop 1
    v_add_f32_dpp v40, v40, v40 row_ror:1 row_mask:0xf bank_mask:0xf
    v_mov_b32 v41, v40
    s_nop 1
    v_permlane16_swap_b32 v40, v41
    v_add_f32_e64 v40, v40, v41
    v_mul_f32 v40, 0x3b124925, v40
    v_cvt_pk_bf16_f32 v41, 0, v40
    v_mul_f32 v43, v41, v44
    v_sub_f32 v40, v40, v41
    v_dot2_f32_bf16 v64, v80, s11, v43
    v_dot2_f32_bf16 v65, v80, s15, v43
    v_dot2_f32_bf16 v66, v81, s11, v43
    v_dot2_f32_bf16 v67, v81, s15, v43
    v_dot2_f32_bf16 v68, v82, s11, v43
    v_dot2_f32_bf16 v69, v82, s15, v43
    v_dot2_f32_bf16 v70, v83, s11, v43
    v_dot2_f32_bf16 v71, v83, s15, v43
    v_dot2_f32_bf16 v72, v84, s11, v43
    v_dot2_f32_bf16 v73, v84, s15, v43
    v_dot2_f32_bf16 v74, v85, s11, v43
    v_dot2_f32_bf16 v75, v85, s15, v43
    v_dot2_f32_bf16 v76, v86, s11, v43
    v_dot2_f32_bf16 v77, v86, s15, v43
    v_dot2_f32_bf16 v78, v87, s11, v43
    v_dot2_f32_bf16 v79, v87, s15, v43
    v_cvt_pk_bf16_f32 v20, v64, v65
    v_cvt_pk_bf16_f32 v21, v66, v67
    v_cvt_pk_bf16_f32 v22, v68, v69
    v_cvt_pk_bf16_f32 v23, v70, v71
    v_cvt_pk_bf16_f32 v24, v72, v73
    v_cvt_pk_bf16_f32 v25, v74, v75
    v_cvt_pk_bf16_f32 v26, v76, v77
    v_cvt_pk_bf16_f32 v27, v78, v79
    s_waitcnt vmcnt(7)
    s_nop 0
    v_dot2_f32_bf16 v41, v20, v20, 0
    v_dot2_f32_bf16 v42, v20, v12, 0
    v_dot2_f32_bf16 v41, v21, v21, v41
    v_dot2_f32_bf16 v42, v21, v13, v42
    v_dot2_f32_bf16 v41, v22, v22, v41
    v_dot2_f32_bf16 v42, v22, v14, v42
    v_dot2_f32_bf16 v41, v23, v23, v41
    v_dot2_f32_bf16 v42, v23, v15, v42
    v_dot2_f32_bf16 v41, v24, v24, v41
    v_dot2_f32_bf16 v42, v24, v16, v42
    v_dot2_f32_bf16 v41, v25, v25, v41
    v_dot2_f32_bf16 v42, v25, v17, v42
    v_dot2_f32_bf16 v41, v26, v26, v41
    v_dot2_f32_bf16 v42, v26, v18, v42
    v_dot2_f32_bf16 v41, v27, v27, v41
    v_dot2_f32_bf16 v42, v27, v19, v42
    v_mul_f32 v40, v40, v40
    v_lshlrev_b32 v64, 16, v20
    v_add_f32_dpp v41, v41, v41 row_ror:8 row_mask:0xf bank_mask:0xf
    v_add_f32_dpp v42, v42, v42 row_ror:8 row_mask:0xf bank_mask:0xf
    v_and_b32 v65, 0xffff0000, v20
    v_add_f32_dpp v41, v41, v41 row_ror:4 row_mask:0xf bank_mask:0xf
    v_add_f32_dpp v42, v42, v42 row_ror:4 row_mask:0xf bank_mask:0xf
    v_lshlrev_b32_e64 v66, 16, v21
    v_add_f32_dpp v41, v41, v41 row_ror:2 row_mask:0xf bank_mask:0xf
    v_add_f32_dpp v42, v42, v42 row_ror:2 row_mask:0xf bank_mask:0xf
    v_and_b32 v67, 0xffff0000, v21
    v_add_f32_dpp v41, v41, v41 row_ror:1 row_mask:0xf bank_mask:0xf
    v_add_f32_dpp v42, v42, v42 row_ror:1 row_mask:0xf bank_mask:0xf
    v_lshlrev_b32 v68, 16, v22
    v_mov_b32 v12, v41
    v_mov_b32_e64 v13, v42
    v_and_b32 v69, 0xffff0000, v22
    v_lshlrev_b32 v70, 16, v23
    v_permlane16_swap_b32 v41, v12
    v_permlane16_swap_b32 v42, v13
    v_add_f32 v41, v41, v12
    v_add_f32_e64 v42, v42, v13
    v_mul_f32 v41, 0x3b124925, v41
    v_and_b32 v71, 0xffff0000, v23
    v_sub_f32 v41, v41, v40
    v_lshlrev_b32 v72, 16, v24
    v_max_f32_e64 v41, 0, v41
    v_and_b32 v73, 0xffff0000, v24
    v_cvt_pk_bf16_f32 v41, 0, v41
    v_lshlrev_b32_e64 v74, 16, v25
    v_add_f32 v41, 0x3727c5ac, v41
    v_and_b32 v75, 0xffff0000, v25
    v_cvt_pk_bf16_f32 v41, 0, v41
    v_lshlrev_b32 v76, 16, v26
    v_sqrt_f32 v41, v41
    v_and_b32 v77, 0xffff0000, v26
    v_cvt_pk_bf16_f32 v41, 0, v41
    v_lshlrev_b32 v78, 16, v27
    v_rcp_f32 v41, v41
    v_and_b32 v79, 0xffff0000, v27
    v_mul_f32 v40, 0x3d000000, v41
    v_mul_f32_e64 v42, v42, v41
    v_pk_mul_f32 v[64:65], v[64:65], v[40:41] op_sel_hi:[1,0]
    v_pk_mul_f32 v[66:67], v[66:67], v[40:41] op_sel_hi:[1,0]
    v_pk_mul_f32 v[68:69], v[68:69], v[40:41] op_sel_hi:[1,0]
    v_pk_mul_f32 v[70:71], v[70:71], v[40:41] op_sel_hi:[1,0]
    v_pk_mul_f32 v[72:73], v[72:73], v[40:41] op_sel_hi:[1,0]
    v_pk_mul_f32 v[74:75], v[74:75], v[40:41] op_sel_hi:[1,0]
    v_pk_mul_f32 v[76:77], v[76:77], v[40:41] op_sel_hi:[1,0]
    v_pk_mul_f32 v[78:79], v[78:79], v[40:41] op_sel_hi:[1,0]
    v_cvt_pkrtz_f16_f32 v20, v64, v65
    v_cvt_pkrtz_f16_f32 v21, v66, v67
    v_cvt_pkrtz_f16_f32 v22, v68, v69
    v_cvt_pkrtz_f16_f32 v23, v70, v71
    v_add_u32 v20, 0x40004, v20
    v_add_u32 v21, 0x40004, v21
    v_add_u32 v22, 0x40004, v22
    v_add_u32 v23, 0x40004, v23
    v_bfi_b32 v20, v3, v93, v20
    v_bfi_b32 v21, v3, v93, v21
    v_bfi_b32 v22, v3, v93, v22
    v_bfi_b32 v23, v3, v93, v23
    ds_write_b128 v37, v[20:23]
    v_cvt_pkrtz_f16_f32 v24, v72, v73
    v_cvt_pkrtz_f16_f32 v25, v74, v75
    v_cvt_pkrtz_f16_f32 v26, v76, v77
    v_cvt_pkrtz_f16_f32 v27, v78, v79
    v_add_u32 v24, 0x40004, v24
    v_add_u32 v25, 0x40004, v25
    v_add_u32 v26, 0x40004, v26
    v_add_u32 v27, 0x40004, v27
    v_bfi_b32 v24, v3, v93, v24
    v_bfi_b32 v25, v3, v93, v25
    v_bfi_b32 v26, v3, v93, v26
    v_bfi_b32 v27, v3, v93, v27
    ds_write_b128 v36, v[24:27] offset:448
    v_cvt_pk_bf16_f32 v42, 0, v42
    v_ashrrev_i32_e64 v13, 31, v42
    v_bitop3_b32 v42, v42, v13, s14 bitop3:0x1e
    v_bfi_b32 v42, v94, v46, v42
    ds_write_b32 v45, v42
    ds_write_b32 v10, v3 offset:20
    s_cmp_eq_u32 s3, 3
    s_cbranch_scc1 L_pub3
L_pspin:
    ds_read_b32 v12, v92
    ds_read_b64_tr_b16 v[20:21], v31
    ds_read_b64_tr_b16 v[22:23], v31 offset:3840
    ds_read_b64_tr_b16 v[24:25], v31 offset:512
    ds_read_b64_tr_b16 v[26:27], v31 offset:4352
    s_waitcnt lgkmcnt(4)
    v_cmp_eq_u32 vcc, 0, v12
    s_nop 0
    s_and_b64 s[10:11], vcc, s[12:13]
    s_cbranch_scc1 L_pspin
    s_waitcnt lgkmcnt(2)
    buffer_store_dwordx4 v[20:23], v39, s[60:63], s9 offen sc1
    s_waitcnt lgkmcnt(0)
    buffer_store_dwordx4 v[24:27], v39, s[60:63], s4 offen sc1
L_pub:
    s_waitcnt vmcnt(3)
L_pubx:
    s_cmp_ge_u32 s2, 224
    s_cbranch_scc1 L_other
    s_setprio 0
L_kgen:
    v_mul_f32 v48, v48, v106
    v_mul_f32 v49, v49, v107
    v_mul_f32 v12, v53, v51
    v_mul_f32 v13, v53, v50
    v_exp_f32 v58, v48
    v_rndne_f32 v20, v49
    v_fma_f32 v60, v52, v50, -v12
    v_sub_f32_e64 v49, v49, v20
    v_fma_f32 v61, -v52, v51, -v13
    v_cos_f32 v54, v49
    v_sin_f32 v55, v49
    v_max_f32_e64 v19, |v60|, |v61|
    v_pk_mul_f32 v[54:55], v[54:55], v[58:59] op_sel_hi:[1,0]
    s_cmp_lt_u32 s3, 3
    s_cbranch_scc1 L_nohf
    s_cmp_eq_u32 s3, 3
    s_cbranch_scc1 L_best
    s_bitcmp1_b32 64, s3
    s_cbranch_scc0 L_nopfe
    s_cmp_eq_u32 s3, 6
    s_cselect_b64 s[46:47], s[42:43], s[38:39]
    s_cmp_eq_u32 s3, 5
    s_cselect_b64 s[46:47], s[40:41], s[46:47]
    global_load_dword v2, v109, s[46:47]
L_nopfe:
L_nohf:
    v_pk_mul_f32 v[56:57], v[54:55], v[54:55] op_sel_hi:[1,0]
    v_cvt_pk_f16_f32 v14, v54, v55
    v_pk_fma_f32 v[56:57], v[54:55], v[54:55], v[56:57] op_sel:[1,1,0] op_sel_hi:[0,1,1] neg_lo:[0,1,0]
    v_max_u32_dpp v19, v19, v19 row_shr:1 row_mask:0xf bank_mask:0xf
    v_pk_mul_f32 v[54:55], v[56:57], v[56:57] op_sel_hi:[1,0]
    v_cvt_pk_f16_f32 v15, v56, v57
    v_pk_fma_f32 v[54:55], v[56:57], v[56:57], v[54:55] op_sel:[1,1,0] op_sel_hi:[0,1,1] neg_lo:[0,1,0]
    v_max_u32_dpp v19, v19, v19 row_shr:2 row_mask:0xf bank_mask:0xf
    v_pk_mul_f32 v[56:57], v[54:55], v[54:55] op_sel_hi:[1,0]
    v_cvt_pk_f16_f32 v16, v54, v55
    v_pk_fma_f32 v[56:57], v[54:55], v[54:55], v[56:57] op_sel:[1,1,0] op_sel_hi:[0,1,1] neg_lo:[0,1,0]
    v_max_u32_dpp v19, v19, v19 row_shr:4 row_mask:0xf bank_mask:0xf
    v_pk_mul_f32 v[54:55], v[56:57], v[56:57] op_sel_hi:[1,0]
    v_cvt_pk_f16_f32 v193, v56, v57
    v_pk_fma_f32 v[54:55], v[56:57], v[56:57], v[54:55] op_sel:[1,1,0] op_sel_hi:[0,1,1] neg_lo:[0,1,0]
    v_max_u32_dpp v19, v19, v19 row_shr:8 row_mask:0xf bank_mask:0xf
    v_pk_mul_f32 v[56:57], v[54:55], v[54:55] op_sel_hi:[1,0]
    v_cvt_pk_f16_f32 v194, v54, v55
    v_pk_fma_f32 v[56:57], v[54:55], v[54:55], v[56:57] op_sel:[1,1,0] op_sel_hi:[0,1,1] neg_lo:[0,1,0]
    v_max_u32_dpp v19, v19, v19 row_bcast:15 row_mask:0xa bank_mask:0xf
    v_pk_mul_f32 v[54:55], v[56:57], v[56:57] op_sel_hi:[1,0]
    v_cvt_pk_f16_f32 v196, v56, v57
    v_pk_fma_f32 v[54:55], v[56:57], v[56:57], v[54:55] op_sel:[1,1,0] op_sel_hi:[0,1,1] neg_lo:[0,1,0]
    v_max_u32_dpp v19, v19, v19 row_bcast:31 row_mask:0xc bank_mask:0xf
    v_pk_mul_f32 v[56:57], v[54:55], v[54:55] op_sel_hi:[1,0]
    v_cvt_pk_f16_f32 v200, v54, v55
    v_pk_fma_f32 v[56:57], v[54:55], v[54:55], v[56:57] op_sel:[1,1,0] op_sel_hi:[0,1,1] neg_lo:[0,1,0]
    v_readlane_b32 s9, v19, 63
    v_pk_mul_f32 v[54:55], v[56:57], v[56:57] op_sel_hi:[1,0]
    v_cvt_pk_f16_f32 v208, v56, v57
    v_pk_fma_f32 v[54:55], v[56:57], v[56:57], v[54:55] op_sel:[1,1,0] op_sel_hi:[0,1,1] neg_lo:[0,1,0]
    s_lshr_b32 s9, s9, 23
    s_max_u32 s9, s9, 8
    s_sub_u32 s10, 258, s9
    s_lshl_b32 s10, s10, 23
    v_mov_b32 v19, s9
    v_pk_mul_f32 v[60:61], v[60:61], s[10:11] op_sel_hi:[1,0]
    ds_write_b32 v10, v19 offset:16
    ds_write_addtid_b32 v193 offset:272
    ds_write_addtid_b32 v194 offset:544
    ds_write_addtid_b32 v196 offset:1088
    ds_write_addtid_b32 v200 offset:2176
    ds_write_addtid_b32 v208 offset:4352
    v_pk_mul_f16 v195, v194, v193 op_sel:[0,0] op_sel_hi:[1,0]
    v_pk_mul_f16 v197, v196, v193 op_sel:[0,0] op_sel_hi:[1,0]
    v_pk_fma_f16 v195, v194, v193, v195 op_sel:[1,1,0] op_sel_hi:[0,1,1] neg_lo:[0,1,0]
    v_pk_fma_f16 v197, v196, v193, v197 op_sel:[1,1,0] op_sel_hi:[0,1,1] neg_lo:[0,1,0]
    v_pk_mul_f16 v198, v196, v194 op_sel:[0,0] op_sel_hi:[1,0]
    v_pk_mul_f16 v201, v200, v193 op_sel:[0,0] op_sel_hi:[1,0]
    v_pk_fma_f16 v198, v196, v194, v198 op_sel:[1,1,0] op_sel_hi:[0,1,1] neg_lo:[0,1,0]
    v_pk_fma_f16 v201, v200, v193, v201 op_sel:[1,1,0] op_sel_hi:[0,1,1] neg_lo:[0,1,0]
    v_pk_mul_f16 v199, v196, v195 op_sel:[0,0] op_sel_hi:[1,0]
    v_pk_mul_f16 v202, v200, v194 op_sel:[0,0] op_sel_hi:[1,0]
    v_pk_fma_f16 v199, v196, v195, v199 op_sel:[1,1,0] op_sel_hi:[0,1,1] neg_lo:[0,1,0]
    v_pk_fma_f16 v202, v200, v194, v202 op_sel:[1,1,0] op_sel_hi:[0,1,1] neg_lo:[0,1,0]
    v_pk_mul_f16 v203, v200, v195 op_sel:[0,0] op_sel_hi:[1,0]
    v_pk_mul_f16 v204, v200, v196 op_sel:[0,0] op_sel_hi:[1,0]
    v_pk_fma_f16 v203, v200, v195, v203 op_sel:[1,1,0] op_sel_hi:[0,1,1] neg_lo:[0,1,0]
    v_pk_fma_f16 v204, v200, v196, v204 op_sel:[1,1,0] op_sel_hi:[0,1,1] neg_lo:[0,1,0]
    ds_write_addtid_b32 v195 offset:816
    ds_write_addtid_b32 v197 offset:1360
    ds_write_addtid_b32 v198 offset:1632
    ds_write_addtid_b32 v201 offset:2448
    ds_write_addtid_b32 v199 offset:1904
    ds_write_addtid_b32 v202 offset:2720
    ds_write_addtid_b32 v203 offset:2992
    ds_write_addtid_b32 v204 offset:3264
    v_pk_mul_f16 v205, v200, v197 op_sel:[0,0] op_sel_hi:[1,0]
    v_pk_mul_f16 v206, v200, v198 op_sel:[0,0] op_sel_hi:[1,0]
    v_pk_fma_f16 v205, v200, v197, v205 op_sel:[1,1,0] op_sel_hi:[0,1,1] neg_lo:[0,1,0]
    v_pk_fma_f16 v206, v200, v198, v206 op_sel:[1,1,0] op_sel_hi:[0,1,1] neg_lo:[0,1,0]
    v_pk_mul_f16 v207, v200, v199 op_sel:[0,0] op_sel_hi:[1,0]
    v_pk_mul_f16 v238, v208, v193 op_sel:[0,0] op_sel_hi:[1,0]
    v_pk_fma_f16 v207, v200, v199, v207 op_sel:[1,1,0] op_sel_hi:[0,1,1] neg_lo:[0,1,0]
    v_pk_fma_f16 v238, v208, v193, v238 op_sel:[1,1,0] op_sel_hi:[0,1,1] neg_lo:[0,1,0]
    v_pk_mul_f16 v239, v208, v194 op_sel:[0,0] op_sel_hi:[1,0]
    v_pk_mul_f16 v240, v208, v195 op_sel:[0,0] op_sel_hi:[1,0]
    v_pk_fma_f16 v239, v208, v194, v239 op_sel:[1,1,0] op_sel_hi:[0,1,1] neg_lo:[0,1,0]
    v_pk_fma_f16 v240, v208, v195, v240 op_sel:[1,1,0] op_sel_hi:[0,1,1] neg_lo:[0,1,0]
    v_pk_mul_f16 v241, v208, v196 op_sel:[0,0] op_sel_hi:[1,0]
    v_pk_mul_f16 v242, v208, v197 op_sel:[0,0] op_sel_hi:[1,0]
    v_pk_fma_f16 v241, v208, v196, v241 op_sel:[1,1,0] op_sel_hi:[0,1,1] neg_lo:[0,1,0]
    v_pk_fma_f16 v242, v208, v197, v242 op_sel:[1,1,0] op_sel_hi:[0,1,1] neg_lo:[0,1,0]
    ds_write_addtid_b32 v205 offset:3536
    ds_write_addtid_b32 v206 offset:3808
    ds_write_addtid_b32 v207 offset:4080
    ds_write_addtid_b32 v238 offset:4624
    ds_write_addtid_b32 v239 offset:4896
    ds_write_addtid_b32 v240 offset:5168
    ds_write_addtid_b32 v241 offset:5440
    ds_write_addtid_b32 v242 offset:5712
    v_pk_mul_f16 v243, v208, v198 op_sel:[0,0] op_sel_hi:[1,0]
    v_pk_mul_f16 v244, v208, v199 op_sel:[0,0] op_sel_hi:[1,0]
    v_pk_fma_f16 v243, v208, v198, v243 op_sel:[1,1,0] op_sel_hi:[0,1,1] neg_lo:[0,1,0]
    v_pk_fma_f16 v244, v208, v199, v244 op_sel:[1,1,0] op_sel_hi:[0,1,1] neg_lo:[0,1,0]
    v_pk_mul_f16 v245, v208, v200 op_sel:[0,0] op_sel_hi:[1,0]
    v_pk_mul_f16 v246, v208, v201 op_sel:[0,0] op_sel_hi:[1,0]
    v_pk_fma_f16 v245, v208, v200, v245 op_sel:[1,1,0] op_sel_hi:[0,1,1] neg_lo:[0,1,0]
    v_pk_fma_f16 v246, v208, v201, v246 op_sel:[1,1,0] op_sel_hi:[0,1,1] neg_lo:[0,1,0]
    v_pk_mul_f16 v247, v208, v202 op_sel:[0,0] op_sel_hi:[1,0]
    v_pk_mul_f16 v248, v208, v203 op_sel:[0,0] op_sel_hi:[1,0]
    v_pk_fma_f16 v247, v208, v202, v247 op_sel:[1,1,0] op_sel_hi:[0,1,1] neg_lo:[0,1,0]
    v_pk_fma_f16 v248, v208, v203, v248 op_sel:[1,1,0] op_sel_hi:[0,1,1] neg_lo:[0,1,0]
    v_pk_mul_f16 v249, v208, v204 op_sel:[0,0] op_sel_hi:[1,0]
    v_pk_mul_f16 v250, v208, v205 op_sel:[0,0] op_sel_hi:[1,0]
    v_pk_fma_f16 v249, v208, v204, v249 op_sel:[1,1,0] op_sel_hi:[0,1,1] neg_lo:[0,1,0]
    v_pk_fma_f16 v250, v208, v205, v250 op_sel:[1,1,0] op_sel_hi:[0,1,1] neg_lo:[0,1,0]
    ds_write_addtid_b32 v243 offset:5984
    ds_write_addtid_b32 v244 offset:6256
    ds_write_addtid_b32 v245 offset:6528
    ds_write_addtid_b32 v246 offset:6800
    ds_write_addtid_b32 v247 offset:7072
    ds_write_addtid_b32 v248 offset:7344
    ds_write_addtid_b32 v249 offset:7616
    ds_write_addtid_b32 v250 offset:7888
    v_pk_mul_f16 v251, v208, v206 op_sel:[0,0] op_sel_hi:[1,0]
    v_pk_mul_f16 v252, v208, v207 op_sel:[0,0] op_sel_hi:[1,0]
    v_pk_fma_f16 v251, v208, v206, v251 op_sel:[1,1,0] op_sel_hi:[0,1,1] neg_lo:[0,1,0]
    v_pk_fma_f16 v252, v208, v207, v252 op_sel:[1,1,0] op_sel_hi:[0,1,1] neg_lo:[0,1,0]
    ds_write_addtid_b32 v251 offset:8160
    ds_write_addtid_b32 v252 offset:8432
    ds_read_b128 v[128:131], v110 offset:0
    ds_read_b128 v[132:135], v110 offset:32
    ds_read_b128 v[136:139], v110 offset:64
    ds_read_b128 v[140:143], v110 offset:96
    ds_read_b128 v[144:147], v110 offset:128
    ds_read_b128 v[148:151], v110 offset:160
    ds_read_b128 v[152:155], v110 offset:192
    ds_read_b128 v[156:159], v110 offset:224
    v_cvt_pk_f16_f32 v216, v60, v61
    v_pk_mul_f32 v[62:63], v[60:61], v[54:55] op_sel_hi:[1,0]
    v_pk_mul_f16 v226, v216, v14 op_sel:[0,0] op_sel_hi:[1,0]
    v_pk_fma_f32 v[62:63], v[60:61], v[54:55], v[62:63] op_sel:[1,1,0] op_sel_hi:[0,1,1] neg_hi:[0,1,0]
    v_pk_fma_f16 v226, v216, v14, v226 op_sel:[1,1,0] op_sel_hi:[0,1,1] neg_hi:[0,1,0]
    v_cvt_pk_f16_f32 v217, v62, v63
    v_pk_mul_f32 v[12:13], v[62:63], v[54:55] op_sel_hi:[1,0]
    v_pk_mul_f16 v227, v216, v15 op_sel:[0,0] op_sel_hi:[1,0]
    v_pk_fma_f32 v[12:13], v[62:63], v[54:55], v[12:13] op_sel:[1,1,0] op_sel_hi:[0,1,1] neg_hi:[0,1,0]
    v_pk_fma_f16 v227, v216, v15, v227 op_sel:[1,1,0] op_sel_hi:[0,1,1] neg_hi:[0,1,0]
    v_cvt_pk_f16_f32 v218, v12, v13
    v_pk_mul_f32 v[62:63], v[12:13], v[54:55] op_sel_hi:[1,0]
    v_pk_mul_f16 v229, v216, v16 op_sel:[0,0] op_sel_hi:[1,0]
    v_pk_fma_f32 v[62:63], v[12:13], v[54:55], v[62:63] op_sel:[1,1,0] op_sel_hi:[0,1,1] neg_hi:[0,1,0]
    v_pk_fma_f16 v229, v216, v16, v229 op_sel:[1,1,0] op_sel_hi:[0,1,1] neg_hi:[0,1,0]
    v_cvt_pk_f16_f32 v219, v62, v63
    v_pk_mul_f32 v[12:13], v[62:63], v[54:55] op_sel_hi:[1,0]
    v_pk_mul_f16 v233, v217, v15 op_sel:[0,0] op_sel_hi:[1,0]
    v_pk_fma_f32 v[12:13], v[62:63], v[54:55], v[12:13] op_sel:[1,1,0] op_sel_hi:[0,1,1] neg_hi:[0,1,0]
    v_pk_fma_f16 v233, v217, v15, v233 op_sel:[1,1,0] op_sel_hi:[0,1,1] neg_hi:[0,1,0]
    v_cvt_pk_f16_f32 v220, v12, v13
    ds_write_addtid_b32 v216 offset:8704
    ds_write_addtid_b32 v226 offset:8976
    ds_write_addtid_b32 v217 offset:10880
    ds_write_addtid_b32 v227 offset:9248
    ds_write_addtid_b32 v218 offset:11968
    ds_write_addtid_b32 v229 offset:9792
    ds_write_addtid_b32 v219 offset:13056
    ds_write_addtid_b32 v233 offset:11152
    ds_write_addtid_b32 v220 offset:14144
    v_pk_mul_f32 v[62:63], v[12:13], v[54:55] op_sel_hi:[1,0]
    v_pk_mul_f16 v228, v227, v14 op_sel:[0,0] op_sel_hi:[1,0]
    v_pk_fma_f32 v[62:63], v[12:13], v[54:55], v[62:63] op_sel:[1,1,0] op_sel_hi:[0,1,1] neg_hi:[0,1,0]
    v_pk_fma_f16 v228, v227, v14, v228 op_sel:[1,1,0] op_sel_hi:[0,1,1] neg_hi:[0,1,0]
    v_cvt_pk_f16_f32 v221, v62, v63
    v_pk_mul_f32 v[12:13], v[62:63], v[54:55] op_sel_hi:[1,0]
    v_pk_mul_f16 v234, v217, v16 op_sel:[0,0] op_sel_hi:[1,0]
    v_pk_fma_f32 v[12:13], v[62:63], v[54:55], v[12:13] op_sel:[1,1,0] op_sel_hi:[0,1,1] neg_hi:[0,1,0]
    v_pk_fma_f16 v234, v217, v16, v234 op_sel:[1,1,0] op_sel_hi:[0,1,1] neg_hi:[0,1,0]
    v_cvt_pk_f16_f32 v222, v12, v13
    v_pk_mul_f32 v[62:63], v[12:13], v[54:55] op_sel_hi:[1,0]
    v_pk_mul_f16 v230, v229, v14 op_sel:[0,0] op_sel_hi:[1,0]
    v_pk_fma_f32 v[62:63], v[12:13], v[54:55], v[62:63] op_sel:[1,1,0] op_sel_hi:[0,1,1] neg_hi:[0,1,0]
    v_pk_fma_f16 v230, v229, v14, v230 op_sel:[1,1,0] op_sel_hi:[0,1,1] neg_hi:[0,1,0]
    v_cvt_pk_f16_f32 v223, v62, v63
    v_pk_mul_f32 v[12:13], v[62:63], v[54:55] op_sel_hi:[1,0]
    v_pk_mul_f16 v231, v229, v15 op_sel:[0,0] op_sel_hi:[1,0]
    v_pk_fma_f32 v[12:13], v[62:63], v[54:55], v[12:13] op_sel:[1,1,0] op_sel_hi:[0,1,1] neg_hi:[0,1,0]
    v_pk_fma_f16 v231, v229, v15, v231 op_sel:[1,1,0] op_sel_hi:[0,1,1] neg_hi:[0,1,0]
    v_cvt_pk_f16_f32 v224, v12, v13
    ds_write_addtid_b32 v228 offset:9520
    ds_write_addtid_b32 v221 offset:13600
    ds_write_addtid_b32 v234 offset:11424
    ds_write_addtid_b32 v222 offset:14688
    ds_write_addtid_b32 v230 offset:10064
    ds_write_addtid_b32 v223 offset:13872
    ds_write_addtid_b32 v231 offset:10336
    ds_write_addtid_b32 v224 offset:14960
    v_pk_mul_f16 v236, v218, v16 op_sel:[0,0] op_sel_hi:[1,0]
    v_pk_mul_f16 v235, v234, v15 op_sel:[0,0] op_sel_hi:[1,0]
    v_pk_fma_f16 v236, v218, v16, v236 op_sel:[1,1,0] op_sel_hi:[0,1,1] neg_hi:[0,1,0]
    v_pk_fma_f16 v235, v234, v15, v235 op_sel:[1,1,0] op_sel_hi:[0,1,1] neg_hi:[0,1,0]
    v_pk_mul_f16 v232, v231, v14 op_sel:[0,0] op_sel_hi:[1,0]
    v_pk_mul_f16 v237, v219, v16 op_sel:[0,0] op_sel_hi:[1,0]
    v_pk_fma_f16 v232, v231, v14, v232 op_sel:[1,1,0] op_sel_hi:[0,1,1] neg_hi:[0,1,0]
    v_pk_fma_f16 v237, v219, v16, v237 op_sel:[1,1,0] op_sel_hi:[0,1,1] neg_hi:[0,1,0]
    ds_write_addtid_b32 v236 offset:12512
    ds_write_addtid_b32 v235 offset:11696
    ds_write_addtid_b32 v232 offset:10608
    ds_write_addtid_b32 v237 offset:13328
    ds_read_b128 v[160:163], v111 offset:8704
    ds_read_b128 v[164:167], v111 offset:8736
    ds_read_b128 v[168:171], v111 offset:8768
    ds_read_b128 v[172:175], v111 offset:8800
    ds_read_b128 v[176:179], v111 offset:8832
    ds_read_b128 v[180:183], v111 offset:8864
    ds_read_b128 v[184:187], v111 offset:8896
    ds_read_b128 v[188:191], v111 offset:8928
    s_cmp_ge_u32 s3, 4
    s_cbranch_scc1 L_help
    s_cmp_ge_u32 s3, 2
    s_cbranch_scc1 L_expB
    ds_read2_b32 v[22:23], v120 offset0:0 offset1:16
    ds_read_b32 v21, v117 offset:16
    ds_read2st64_b32 v[80:81], v113 offset0:0 offset1:1
    ds_read2st64_b32 v[90:91], v113 offset0:119 offset1:120
    ds_read2st64_b32 v[82:83], v113 offset0:2 offset1:3
    ds_read2st64_b32 v[92:93], v113 offset0:121 offset1:122
    s_waitcnt lgkmcnt(13)
    v_mfma_f32_32x32x16_f16 v[64:79], v[160:163], v[128:131], 0
    ds_read2st64_b32 v[84:85], v113 offset0:10 offset1:11
    ds_read2st64_b32 v[94:95], v113 offset0:129 offset1:130
    s_waitcnt lgkmcnt(14)
    v_mfma_f32_32x32x16_f16 v[64:79], v[164:167], v[132:135], v[64:79]
    s_waitcnt lgkmcnt(13)
    v_mfma_f32_32x32x16_f16 v[64:79], v[168:171], v[136:139], v[64:79]
    s_waitcnt lgkmcnt(12)
    v_mfma_f32_32x32x16_f16 v[64:79], v[172:175], v[140:143], v[64:79]
    s_waitcnt lgkmcnt(6)
L_hcA:
    v_min3_u32 v12, v21, v22, v23
    v_max3_u32 v14, v21, v22, v23
    v_cmp_eq_u32 vcc, 0, v12
    s_nop 0
    s_cbranch_vccnz L_hrA
    v_mfma_f32_32x32x16_f16 v[64:79], v[176:179], v[144:147], v[64:79]
    v_max_u32 v14, v14, v19
    v_sub_u32 v22, v22, v14
    v_sub_u32_e64 v23, v23, v14
    v_ldexp_f32 v22, 1.0, v22
    v_mfma_f32_32x32x16_f16 v[64:79], v[180:183], v[148:151], v[64:79]
    s_waitcnt lgkmcnt(0)
    s_nop 0
    v_pk_mul_f32 v[80:81], v[80:81], v[22:23] op_sel_hi:[1,0]
    v_pk_mul_f32 v[82:83], v[82:83], v[22:23] op_sel_hi:[1,0]
    v_pk_mul_f32 v[84:85], v[84:85], v[22:23] op_sel_hi:[1,0]
    v_mfma_f32_32x32x16_f16 v[64:79], v[184:187], v[152:155], v[64:79]
    v_ldexp_f32 v23, 1.0, v23
    v_sub_u32 v20, v19, v14
    v_sub_u32 v21, v21, v14
    v_add_u32 v14, -121, v14
    v_mfma_f32_32x32x16_f16 v[64:79], v[188:191], v[156:159], v[64:79]
    v_pk_fma_f32 v[80:81], v[90:91], v[22:23], v[80:81] op_sel:[0,1,0] op_sel_hi:[1,1,1]
    v_pk_fma_f32 v[82:83], v[92:93], v[22:23], v[82:83] op_sel:[0,1,0] op_sel_hi:[1,1,1]
    v_pk_fma_f32 v[84:85], v[94:95], v[22:23], v[84:85] op_sel:[0,1,0] op_sel_hi:[1,1,1]
    v_ldexp_f32 v18, v105, v14
    v_ldexp_f32 v20, 1.0, v20
    v_ldexp_f32 v21, 1.0, v21
    v_readfirstlane_b32 s28, v18
    s_nop 4
    ds_write_addtid_b32 v68 offset:1024
    ds_write_addtid_b32 v69 offset:1280
    ds_write_addtid_b32 v72 offset:2048
    ds_write_addtid_b32 v73 offset:2304
    ds_write_addtid_b32 v70 offset:1536
    ds_write_addtid_b32 v71 offset:1792
    ds_write_addtid_b32 v74 offset:2560
    ds_write_b32 v10, v3 offset:28
    ds_read_b32 v12, v117 offset:28
    ds_read2st64_b32 v[100:101], v114 offset0:0 offset1:1
    ds_read2st64_b32 v[102:103], v114 offset0:2 offset1:3
    ds_read2st64_b32 v[104:105], v114 offset0:10 offset1:11
    v_pk_fma_f32 v[64:65], v[64:65], v[20:21], v[80:81] op_sel_hi:[1,0,1]
    v_pk_fma_f32 v[66:67], v[66:67], v[20:21], v[82:83] op_sel_hi:[1,0,1]
    v_pk_fma_f32 v[74:75], v[74:75], v[20:21], v[84:85] op_sel_hi:[1,0,1]
    s_waitcnt vmcnt(0) lgkmcnt(3)
L_psA:
    v_cmp_eq_u32_e64 vcc, 0, v12
    s_nop 0
    s_cbranch_vccnz L_prA
    s_waitcnt lgkmcnt(0)
    v_pk_fma_f32 v[64:65], v[100:101], v[20:21], v[64:65] op_sel:[0,1,0] op_sel_hi:[1,1,1]
    v_pk_fma_f32 v[66:67], v[102:103], v[20:21], v[66:67] op_sel:[0,1,0] op_sel_hi:[1,1,1]
    v_pk_fma_f32 v[74:75], v[104:105], v[20:21], v[74:75] op_sel:[0,1,0] op_sel_hi:[1,1,1]
    v_cvt_pk_f16_f32 v20, v64, v65
    v_cvt_pk_f16_f32 v21, v66, v67
    v_mov_b32_dpp v82, v75 wave_rol:1 row_mask:0xf bank_mask:0xf
    v_mov_b32_dpp v83, v75 wave_rol:1 row_mask:0xf bank_mask:0xf
    ds_write_b64 v116, v[20:21] offset:64
    v_cvt_pk_f16_f32 v88, v74, v74
    v_mov_b32_dpp v82, v74 wave_shl:1 row_mask:0xf bank_mask:0xf
    v_cvt_pk_f16_f32 v92, v75, v75
    v_bfi_b32 v85, v121, v83, v75
    v_bfi_b32 v84, v121, v82, v74
    v_mov_b32_e64 v89, v88
    v_cvt_pk_f16_f32 v90, v84, v82
    v_cvt_pk_f16_f32 v91, v82, v82
    ds_write_b128 v115, v[88:91] offset:2624
    v_mov_b32_e64 v93, v92
    v_cvt_pk_f16_f32 v94, v85, v83
    v_cvt_pk_f16_f32 v95, v83, v83
    s_mov_b32 exec_hi, 0
    ds_write_b128 v115, v[92:95] offset:3648
    s_mov_b32 exec_hi, -1
    s_waitcnt lgkmcnt(0)
    s_barrier
    s_setprio 2
.p2align 3
    ds_read_b128 v[40:43], v4 offset:64
    ds_read_b64_tr_b16 v[128:129], v5 offset:32
    ds_read_b64_tr_b16 v[130:131], v5 offset:0
    ds_read_b128 v[44:47], v4 offset:576
    ds_read_b64_tr_b16 v[132:133], v5 offset:160
    ds_read_b64_tr_b16 v[134:135], v5 offset:128
    ds_read_b128 v[48:51], v4 offset:448
    ds_read_b64_tr_b16 v[136:137], v5 offset:288
    ds_read_b64_tr_b16 v[138:139], v5 offset:256
    ds_read_b128 v[52:55], v4 offset:320
    ds_read_b64_tr_b16 v[140:141], v5 offset:416
    ds_read_b64_tr_b16 v[142:143], v5 offset:384
    ds_read_b128 v[56:59], v4 offset:192
    ds_read_b64_tr_b16 v[144:145], v5 offset:544
    ds_read_b64_tr_b16 v[146:147], v5 offset:512
    s_waitcnt lgkmcnt(12)
    v_mfma_f32_32x32x16_f16 v[64:79], v[40:43], v[128:131], 0
    ds_read_b128 v[60:63], v4 offset:64
    ds_read_b64_tr_b16 v[148:149], v5 offset:672
    ds_read_b64_tr_b16 v[150:151], v5 offset:640
    s_waitcnt lgkmcnt(14)
    v_mfma_f32_32x32x16_f16 v[80:95], v[44:47], v[128:131], 0
    ds_read_b128 v[40:43], v4 offset:1088
    ds_read_b64_tr_b16 v[152:153], v5 offset:800
    ds_read_b64_tr_b16 v[154:155], v5 offset:768
    s_waitcnt lgkmcnt(14)
    v_mfma_f32_32x32x16_f16 v[80:95], v[48:51], v[132:135], v[80:95]
    ds_read_b128 v[44:47], v4 offset:960
    ds_read_b64_tr_b16 v[156:157], v5 offset:928
    ds_read_b64_tr_b16 v[158:159], v5 offset:896
    s_waitcnt lgkmcnt(11)
    v_mfma_f32_32x32x16_f16 v[80:95], v[52:55], v[136:139], v[80:95]
    ds_read_b128 v[48:51], v4 offset:832
    v_bfi_b32 v21, v6, v73, v77
    v_bfi_b32 v22, v7, v74, v78
    v_bfi_b32 v23, v8, v75, v79
    v_mfma_f32_32x32x16_f16 v[80:95], v[56:59], v[140:143], v[80:95]
    ds_read_b128 v[52:55], v4 offset:704
    v_add_f32_dpp v22, v23, v22 wave_ror:1 row_mask:0xf bank_mask:0xf
    s_waitcnt lgkmcnt(7)
    v_mfma_f32_32x32x16_f16 v[80:95], v[60:63], v[144:147], v[80:95]
    ds_read_b128 v[56:59], v4 offset:576
    v_add_f32_dpp v21, v22, v21 wave_ror:1 row_mask:0xf bank_mask:0xf
    v_mfma_f32_32x32x16_f16 v[96:111], v[40:43], v[128:131], 0
    ds_read_b128 v[60:63], v4 offset:448
    v_add_f32_dpp v27, v21, v76 wave_ror:1 row_mask:0xf bank_mask:0xf
    v_mul_f32_e64 v27, s28, v27
    v_cvt_pk_bf16_f32 v26, v26, v27
    s_waitcnt lgkmcnt(3)
    v_mfma_f32_32x32x16_f16 v[96:111], v[44:47], v[132:135], v[96:111]
    ds_read_b128 v[40:43], v4 offset:320
    ds_write_b16_d16_hi v33, v26 offset:384
    ds_read_b128 v[36:39], v34
    v_mfma_f32_32x32x16_f16 v[96:111], v[48:51], v[136:139], v[96:111]
    ds_read_b128 v[44:47], v4 offset:192
    ds_read_b64_tr_b16 v[160:161], v5 offset:1056
    ds_read_b64_tr_b16 v[162:163], v5 offset:1024
    s_waitcnt lgkmcnt(7)
    v_mfma_f32_32x32x16_f16 v[96:111], v[52:55], v[140:143], v[96:111]
    ds_read_b128 v[48:51], v4 offset:64
    v_bfi_b32 v12, v6, v77, v81
    v_bfi_b32 v13, v7, v78, v82
    v_bfi_b32 v14, v8, v79, v83
    v_bfi_b32 v15, v6, v81, v85
    v_mfma_f32_32x32x16_f16 v[96:111], v[56:59], v[144:147], v[96:111]
    ds_read_b128 v[52:55], v4 offset:3520
    v_bfi_b32 v16, v7, v82, v86
    v_bfi_b32 v17, v8, v83, v87
    v_bfi_b32 v18, v6, v85, v89
    s_waitcnt lgkmcnt(7)
    v_mfma_f32_32x32x16_f16 v[96:111], v[60:63], v[148:151], v[96:111]
    ds_read_b128 v[56:59], v4 offset:3392
    v_bfi_b32 v19, v7, v86, v90
    v_bfi_b32 v20, v8, v87, v91
    v_bfi_b32 v21, v6, v89, v93
    v_bfi_b32 v22, v7, v90, v94
    v_mfma_f32_32x32x16_f16 v[96:111], v[40:43], v[152:155], v[96:111]
    ds_read_b128 v[60:63], v4 offset:3264
    v_bfi_b32 v23, v8, v91, v95
    v_add_f32_dpp v13, v14, v13 wave_ror:1 row_mask:0xf bank_mask:0xf
    v_add_f32_dpp v16, v17, v16 wave_ror:1 row_mask:0xf bank_mask:0xf
    s_waitcnt lgkmcnt(3)
    v_mfma_f32_32x32x16_f16 v[96:111], v[44:47], v[156:159], v[96:111]
    ds_read_b128 v[40:43], v4 offset:3136
    s_add_u32 s31, s30, 4294795264
    s_mov_b32 exec_lo, 0xff000000
    buffer_store_dwordx4 v[36:39], v35, s[60:63], s31 offen sc1
    s_mov_b32 exec_lo, -1
    v_mfma_f32_32x32x16_f16 v[96:111], v[48:51], v[160:163], v[96:111]
    ds_read_b128 v[44:47], v4 offset:3008
    v_add_f32_dpp v19, v20, v19 wave_ror:1 row_mask:0xf bank_mask:0xf
    v_add_f32_dpp v22, v23, v22 wave_ror:1 row_mask:0xf bank_mask:0xf
    v_add_f32_dpp v12, v13, v12 wave_ror:1 row_mask:0xf bank_mask:0xf
    s_waitcnt lgkmcnt(3)
    v_mfma_f32_32x32x16_f16 v[112:127], v[52:55], v[128:131], 0
    ds_read_b128 v[48:51], v4 offset:2880
    v_add_f32_dpp v15, v16, v15 wave_ror:1 row_mask:0xf bank_mask:0xf
    v_add_f32_dpp v18, v19, v18 wave_ror:1 row_mask:0xf bank_mask:0xf
    v_add_f32_dpp v21, v22, v21 wave_ror:1 row_mask:0xf bank_mask:0xf
    v_add_f32_dpp v24, v12, v80 wave_ror:1 row_mask:0xf bank_mask:0xf
    v_mfma_f32_32x32x16_f16 v[112:127], v[56:59], v[132:135], v[112:127]
    ds_read_b128 v[52:55], v4 offset:2752
    v_add_f32_dpp v25, v15, v84 wave_ror:1 row_mask:0xf bank_mask:0xf
    v_add_f32_dpp v26, v18, v88 wave_ror:1 row_mask:0xf bank_mask:0xf
    v_add_f32_dpp v27, v21, v92 wave_ror:1 row_mask:0xf bank_mask:0xf
    s_waitcnt lgkmcnt(3)
    v_mfma_f32_32x32x16_f16 v[112:127], v[60:63], v[136:139], v[112:127]
    ds_read_b128 v[56:59], v4 offset:2624
    v_mul_f32_e64 v24, s28, v24
    v_mul_f32_e64 v25, s28, v25
    v_mul_f32_e64 v26, s28, v26
    v_mul_f32_e64 v27, s28, v27
    v_mfma_f32_32x32x16_f16 v[112:127], v[40:43], v[140:143], v[112:127]
    ds_read_b128 v[60:63], v4 offset:2496
    ds_read_b64_tr_b16 v[164:165], v5 offset:1184
    ds_read_b64_tr_b16 v[166:167], v5 offset:1152
    s_waitcnt lgkmcnt(5)
    v_mfma_f32_32x32x16_f16 v[112:127], v[44:47], v[144:147], v[112:127]
    ds_read_b128 v[40:43], v4 offset:2368
    ds_read_b64_tr_b16 v[168:169], v5 offset:1312
    ds_read_b64_tr_b16 v[170:171], v5 offset:1280
    v_cvt_pk_bf16_f32 v24, v24, v25
    v_mfma_f32_32x32x16_f16 v[112:127], v[48:51], v[148:151], v[112:127]
    ds_read_b128 v[44:47], v4 offset:2240
    ds_read_b64_tr_b16 v[172:173], v5 offset:1440
    ds_read_b64_tr_b16 v[174:175], v5 offset:1408
    s_waitcnt lgkmcnt(9)
    v_mfma_f32_32x32x16_f16 v[112:127], v[52:55], v[152:155], v[112:127]
    ds_read_b128 v[48:51], v4 offset:2112
    ds_read_b64_tr_b16 v[176:177], v5 offset:1568
    ds_read_b64_tr_b16 v[178:179], v5 offset:1536
    v_cvt_pk_bf16_f32 v26, v26, v27
    v_mfma_f32_32x32x16_f16 v[112:127], v[56:59], v[156:159], v[112:127]
    ds_read_b128 v[52:55], v4 offset:1984
    ds_read_b64_tr_b16 v[180:181], v5 offset:1696
    ds_read_b64_tr_b16 v[182:183], v5 offset:1664
    s_waitcnt lgkmcnt(11)
    v_mfma_f32_32x32x16_f16 v[112:127], v[60:63], v[160:163], v[112:127]
    ds_read_b128 v[56:59], v4 offset:1856
    ds_read_b64_tr_b16 v[184:185], v5 offset:1824
    ds_read_b64_tr_b16 v[186:187], v5 offset:1792
    ds_write_b16 v33, v24 offset:0
    v_mfma_f32_32x32x16_f16 v[112:127], v[40:43], v[164:167], v[112:127]
    ds_read_b128 v[60:63], v4 offset:1728
    ds_read_b64_tr_b16 v[188:189], v5 offset:1952
    ds_read_b64_tr_b16 v[190:191], v5 offset:1920
    s_waitcnt lgkmcnt(12)
    v_mfma_f32_32x32x16_f16 v[112:127], v[44:47], v[168:171], v[112:127]
    ds_read_b128 v[40:43], v4 offset:1600
    ds_read_b64_tr_b16 v[192:193], v5 offset:2080
    ds_read_b64_tr_b16 v[194:195], v5 offset:2048
    ds_write_b16_d16_hi v33, v24 offset:128
    v_mfma_f32_32x32x16_f16 v[112:127], v[48:51], v[172:175], v[112:127]
    ds_read_b128 v[44:47], v4 offset:1472
    ds_read_b64_tr_b16 v[196:197], v5 offset:2208
    ds_read_b64_tr_b16 v[198:199], v5 offset:2176
    s_waitcnt lgkmcnt(13)
    v_mfma_f32_32x32x16_f16 v[112:127], v[52:55], v[176:179], v[112:127]
    ds_read_b128 v[48:51], v4 offset:1344
    ds_read_b64_tr_b16 v[200:201], v5 offset:2336
    ds_read_b64_tr_b16 v[202:203], v5 offset:2304
    ds_write_b16 v33, v26 offset:256
    v_mfma_f32_32x32x16_f16 v[112:127], v[56:59], v[180:183], v[112:127]
    ds_read_b128 v[52:55], v4 offset:1216
    ds_read_b64_tr_b16 v[204:205], v5 offset:2464
    ds_read_b64_tr_b16 v[206:207], v5 offset:2432
    s_waitcnt lgkmcnt(13)
    v_mfma_f32_32x32x16_f16 v[112:127], v[60:63], v[184:187], v[112:127]
    ds_read_b128 v[56:59], v4 offset:1088
    ds_read_b64_tr_b16 v[208:209], v5 offset:2592
    ds_read_b64_tr_b16 v[210:211], v5 offset:2560
    ds_write_b16_d16_hi v33, v26 offset:384
    v_mfma_f32_32x32x16_f16 v[112:127], v[40:43], v[188:191], v[112:127]
    ds_read_b128 v[60:63], v4 offset:960
    ds_read_b64_tr_b16 v[212:213], v5 offset:2720
    ds_read_b64_tr_b16 v[214:215], v5 offset:2688
    s_waitcnt lgkmcnt(13)
    v_mfma_f32_32x32x16_f16 v[112:127], v[44:47], v[192:195], v[112:127]
    ds_read_b128 v[40:43], v4 offset:832
    ds_read_b64_tr_b16 v[216:217], v5 offset:2848
    ds_read_b64_tr_b16 v[218:219], v5 offset:2816
    ds_read_b128 v[36:39], v34
    v_mfma_f32_32x32x16_f16 v[112:127], v[48:51], v[196:199], v[112:127]
    ds_read_b128 v[44:47], v4 offset:704
    ds_read_b64_tr_b16 v[220:221], v5 offset:2976
    ds_read_b64_tr_b16 v[222:223], v5 offset:2944
    s_waitcnt lgkmcnt(13)
    v_mfma_f32_32x32x16_f16 v[112:127], v[52:55], v[200:203], v[112:127]
    ds_read_b128 v[48:51], v4 offset:576
    ds_read_b64_tr_b16 v[224:225], v5 offset:3104
    ds_read_b64_tr_b16 v[226:227], v5 offset:3072
    v_bfi_b32 v12, v6, v93, v97
    v_mfma_f32_32x32x16_f16 v[112:127], v[56:59], v[204:207], v[112:127]
    ds_read_b128 v[52:55], v4 offset:448
    ds_read_b64_tr_b16 v[228:229], v5 offset:3232
    ds_read_b64_tr_b16 v[230:231], v5 offset:3200
    s_waitcnt lgkmcnt(12)
    v_mfma_f32_32x32x16_f16 v[112:127], v[60:63], v[208:211], v[112:127]
    ds_read_b128 v[56:59], v4 offset:320
    ds_read_b64_tr_b16 v[232:233], v5 offset:3360
    ds_read_b64_tr_b16 v[234:235], v5 offset:3328
    v_bfi_b32 v13, v7, v94, v98
    v_mfma_f32_32x32x16_f16 v[112:127], v[40:43], v[212:215], v[112:127]
    ds_read_b128 v[60:63], v4 offset:192
    ds_read_b64_tr_b16 v[236:237], v5 offset:3488
    ds_read_b64_tr_b16 v[238:239], v5 offset:3456
    s_waitcnt lgkmcnt(11)
    v_mfma_f32_32x32x16_f16 v[112:127], v[44:47], v[216:219], v[112:127]
    ds_read_b128 v[40:43], v4 offset:64
    s_add_u32 s31, s30, 57344
    buffer_store_dwordx4 v[36:39], v35, s[60:63], s31 offen sc1
    v_bfi_b32 v14, v8, v95, v99
    v_mfma_f32_32x32x16_f16 v[112:127], v[48:51], v[220:223], v[112:127]
    ds_read_b128 v[44:47], v4 offset:4032
    v_bfi_b32 v15, v6, v97, v101
    v_bfi_b32 v16, v7, v98, v102
    v_bfi_b32 v17, v8, v99, v103
    s_waitcnt lgkmcnt(7)
    v_mfma_f32_32x32x16_f16 v[112:127], v[52:55], v[224:227], v[112:127]
    ds_read_b128 v[48:51], v4 offset:3904
    v_bfi_b32 v18, v6, v101, v105
    v_bfi_b32 v19, v7, v102, v106
    v_bfi_b32 v20, v8, v103, v107
    v_bfi_b32 v21, v6, v105, v109
    v_mfma_f32_32x32x16_f16 v[112:127], v[56:59], v[228:231], v[112:127]
    ds_read_b128 v[52:55], v4 offset:3776
    v_bfi_b32 v22, v7, v106, v110
    v_bfi_b32 v23, v8, v107, v111
    v_add_f32_dpp v13, v14, v13 wave_ror:1 row_mask:0xf bank_mask:0xf
    s_waitcnt lgkmcnt(3)
    v_mfma_f32_32x32x16_f16 v[112:127], v[60:63], v[232:235], v[112:127]
    ds_read_b128 v[56:59], v4 offset:3648
    v_add_f32_dpp v16, v17, v16 wave_ror:1 row_mask:0xf bank_mask:0xf
    v_add_f32_dpp v19, v20, v19 wave_ror:1 row_mask:0xf bank_mask:0xf
    v_add_f32_dpp v22, v23, v22 wave_ror:1 row_mask:0xf bank_mask:0xf
    v_add_f32_dpp v12, v13, v12 wave_ror:1 row_mask:0xf bank_mask:0xf
    v_mfma_f32_32x32x16_f16 v[112:127], v[40:43], v[236:239], v[112:127]
    ds_read_b128 v[60:63], v4 offset:3520
    v_add_f32_dpp v15, v16, v15 wave_ror:1 row_mask:0xf bank_mask:0xf
    v_add_f32_dpp v18, v19, v18 wave_ror:1 row_mask:0xf bank_mask:0xf
    v_add_f32_dpp v21, v22, v21 wave_ror:1 row_mask:0xf bank_mask:0xf
    s_waitcnt lgkmcnt(3)
    v_mfma_f32_32x32x16_f16 v[64:79], v[44:47], v[128:131], 0
    ds_read_b128 v[40:43], v4 offset:3392
    v_add_f32_dpp v24, v12, v96 wave_ror:1 row_mask:0xf bank_mask:0xf
    v_add_f32_dpp v25, v15, v100 wave_ror:1 row_mask:0xf bank_mask:0xf
    v_add_f32_dpp v26, v18, v104 wave_ror:1 row_mask:0xf bank_mask:0xf
    v_add_f32_dpp v27, v21, v108 wave_ror:1 row_mask:0xf bank_mask:0xf
    v_mfma_f32_32x32x16_f16 v[64:79], v[48:51], v[132:135], v[64:79]
    ds_read_b128 v[44:47], v4 offset:3264
    v_mul_f32_e64 v24, s28, v24
    v_mul_f32_e64 v25, s28, v25
    v_mul_f32_e64 v26, s28, v26
    s_waitcnt lgkmcnt(3)
    v_mfma_f32_32x32x16_f16 v[64:79], v[52:55], v[136:139], v[64:79]
    ds_read_b128 v[48:51], v4 offset:3136
    v_mul_f32_e64 v27, s28, v27
    v_cvt_pk_bf16_f32 v24, v24, v25
    v_cvt_pk_bf16_f32 v26, v26, v27
    v_mfma_f32_32x32x16_f16 v[64:79], v[56:59], v[140:143], v[64:79]
    ds_read_b128 v[52:55], v4 offset:3008
    ds_write_b16 v33, v24 offset:0
    s_waitcnt lgkmcnt(4)
    v_mfma_f32_32x32x16_f16 v[64:79], v[60:63], v[144:147], v[64:79]
    ds_read_b128 v[56:59], v4 offset:2880
    ds_write_b16_d16_hi v33, v24 offset:128
    ds_write_b16 v33, v26 offset:256
    v_mfma_f32_32x32x16_f16 v[64:79], v[40:43], v[148:151], v[64:79]
    ds_read_b128 v[60:63], v4 offset:2752
    ds_write_b16_d16_hi v33, v26 offset:384
    ds_read_b128 v[36:39], v34
    s_waitcnt lgkmcnt(8)
    v_mfma_f32_32x32x16_f16 v[64:79], v[44:47], v[152:155], v[64:79]
    ds_read_b128 v[40:43], v4 offset:2624
    v_bfi_b32 v15, v6, v113, v117
    v_bfi_b32 v16, v7, v114, v118
    v_bfi_b32 v17, v8, v115, v119
    v_bfi_b32 v18, v6, v117, v121
    v_mfma_f32_32x32x16_f16 v[64:79], v[48:51], v[156:159], v[64:79]
    ds_read_b128 v[44:47], v4 offset:2496
    v_bfi_b32 v19, v7, v118, v122
    v_bfi_b32 v20, v8, v119, v123
    v_bfi_b32 v21, v6, v121, v125
    s_waitcnt lgkmcnt(7)
    v_mfma_f32_32x32x16_f16 v[64:79], v[52:55], v[160:163], v[64:79]
    ds_read_b128 v[48:51], v4 offset:2368
    v_bfi_b32 v22, v7, v122, v126
    v_bfi_b32 v23, v8, v123, v127
    v_add_f32_dpp v13, v115, v114 wave_ror:1 row_mask:0xf bank_mask:0xf
    v_add_f32_dpp v16, v17, v16 wave_ror:1 row_mask:0xf bank_mask:0xf
    v_mfma_f32_32x32x16_f16 v[64:79], v[56:59], v[164:167], v[64:79]
    ds_read_b128 v[52:55], v4 offset:2240
    v_add_f32_dpp v19, v20, v19 wave_ror:1 row_mask:0xf bank_mask:0xf
    v_add_f32_dpp v22, v23, v22 wave_ror:1 row_mask:0xf bank_mask:0xf
    v_add_f32_dpp v12, v13, v113 wave_ror:1 row_mask:0xf bank_mask:0xf
    s_waitcnt lgkmcnt(3)
    v_mfma_f32_32x32x16_f16 v[64:79], v[60:63], v[168:171], v[64:79]
    ds_read_b128 v[56:59], v4 offset:2112
    s_add_u32 s31, s30, 286720
    buffer_store_dwordx4 v[36:39], v35, s[60:63], s31 offen sc1
    v_add_f32_dpp v15, v16, v15 wave_ror:1 row_mask:0xf bank_mask:0xf
    v_mfma_f32_32x32x16_f16 v[64:79], v[40:43], v[172:175], v[64:79]
    ds_read_b128 v[60:63], v4 offset:1984
    v_add_f32_dpp v18, v19, v18 wave_ror:1 row_mask:0xf bank_mask:0xf
    v_add_f32_dpp v21, v22, v21 wave_ror:1 row_mask:0xf bank_mask:0xf
    v_add_f32_dpp v24, v12, v112 wave_ror:1 row_mask:0xf bank_mask:0xf
    s_waitcnt lgkmcnt(3)
    v_mfma_f32_32x32x16_f16 v[64:79], v[44:47], v[176:179], v[64:79]
    ds_read_b128 v[40:43], v4 offset:1856
    v_add_f32_dpp v25, v15, v116 wave_ror:1 row_mask:0xf bank_mask:0xf
    v_add_f32_dpp v26, v18, v120 wave_ror:1 row_mask:0xf bank_mask:0xf
    v_add_f32_dpp v27, v21, v124 wave_ror:1 row_mask:0xf bank_mask:0xf
    v_mul_f32_e64 v24, s28, v24
    v_mfma_f32_32x32x16_f16 v[64:79], v[48:51], v[180:183], v[64:79]
    ds_read_b128 v[44:47], v4 offset:1728
    v_mul_f32_e64 v25, s28, v25
    v_mul_f32_e64 v26, s28, v26
    v_mul_f32_e64 v27, s28, v27
    s_waitcnt lgkmcnt(3)
    v_mfma_f32_32x32x16_f16 v[64:79], v[52:55], v[184:187], v[64:79]
    ds_read_b128 v[48:51], v4 offset:1600
    v_cvt_pk_bf16_f32 v24, v24, v25
    v_cvt_pk_bf16_f32 v26, v26, v27
    ds_write_b16 v33, v24 offset:0
    v_mfma_f32_32x32x16_f16 v[64:79], v[56:59], v[188:191], v[64:79]
    ds_read_b128 v[52:55], v4 offset:1472
    ds_write_b16_d16_hi v33, v24 offset:128
    s_waitcnt lgkmcnt(5)
    v_mfma_f32_32x32x16_f16 v[64:79], v[60:63], v[192:195], v[64:79]
    ds_read_b128 v[56:59], v4 offset:1344
    ds_write_b16 v33, v26 offset:256
    ds_write_b16_d16_hi v33, v26 offset:384
    v_mfma_f32_32x32x16_f16 v[64:79], v[40:43], v[196:199], v[64:79]
    ds_read_b128 v[60:63], v4 offset:1216
    ds_read_b128 v[36:39], v34
    s_waitcnt lgkmcnt(8)
    v_mfma_f32_32x32x16_f16 v[64:79], v[44:47], v[200:203], v[64:79]
    ds_read_b128 v[40:43], v4 offset:1088
    ds_read_b64_tr_b16 v[240:241], v5 offset:3616
    ds_read_b64_tr_b16 v[242:243], v5 offset:3584
    v_mfma_f32_32x32x16_f16 v[64:79], v[48:51], v[204:207], v[64:79]
    ds_read_b128 v[44:47], v4 offset:960
    ds_read_b64_tr_b16 v[244:245], v5 offset:3744
    ds_read_b64_tr_b16 v[246:247], v5 offset:3712
    s_waitcnt lgkmcnt(10)
    v_mfma_f32_32x32x16_f16 v[64:79], v[52:55], v[208:211], v[64:79]
    ds_read_b128 v[48:51], v4 offset:832
    ds_read_b64_tr_b16 v[248:249], v5 offset:3872
    ds_read_b64_tr_b16 v[250:251], v5 offset:3840
    v_mfma_f32_32x32x16_f16 v[64:79], v[56:59], v[212:215], v[64:79]
    ds_read_b128 v[52:55], v4 offset:704
    ds_read_b64_tr_b16 v[252:253], v5 offset:4000
    ds_read_b64_tr_b16 v[254:255], v5 offset:3968
    s_waitcnt lgkmcnt(11)
    v_mfma_f32_32x32x16_f16 v[64:79], v[60:63], v[216:219], v[64:79]
    ds_read_b128 v[56:59], v4 offset:576
    s_add_u32 s31, s30, 1376256
    s_mov_b32 exec_lo, -16
    buffer_store_dwordx4 v[36:39], v35, s[60:63], s31 offen sc1
    s_mov_b32 exec_lo, -1
    v_mfma_f32_32x32x16_f16 v[64:79], v[40:43], v[220:223], v[64:79]
    ds_read_b128 v[60:63], v4 offset:448
    s_waitcnt lgkmcnt(7)
    v_mfma_f32_32x32x16_f16 v[64:79], v[44:47], v[224:227], v[64:79]
    ds_read_b128 v[40:43], v4 offset:320
    v_mfma_f32_32x32x16_f16 v[64:79], v[48:51], v[228:231], v[64:79]
    ds_read_b128 v[44:47], v4 offset:192
    s_waitcnt lgkmcnt(3)
    v_mfma_f32_32x32x16_f16 v[64:79], v[52:55], v[232:235], v[64:79]
    ds_read_b128 v[48:51], v4 offset:64
    v_mfma_f32_32x32x16_f16 v[64:79], v[56:59], v[236:239], v[64:79]
    s_waitcnt lgkmcnt(2)
    v_mfma_f32_32x32x16_f16 v[64:79], v[60:63], v[240:243], v[64:79]
    v_mfma_f32_32x32x16_f16 v[64:79], v[40:43], v[244:247], v[64:79]
    s_waitcnt lgkmcnt(0)
    v_mfma_f32_32x32x16_f16 v[64:79], v[44:47], v[248:251], v[64:79]
    v_mfma_f32_32x32x16_f16 v[64:79], v[48:51], v[252:255], v[64:79]
    s_add_u32 s31, s30, 1605632
    s_nop 10
    s_nop 0
    v_bfi_b32 v12, v6, v125, v65
    v_bfi_b32 v13, v7, v126, v66
    v_bfi_b32 v14, v8, v127, v67
    v_bfi_b32 v15, v6, v65, v69
    v_bfi_b32 v16, v7, v66, v70
    v_bfi_b32 v17, v8, v67, v71
    v_bfi_b32 v18, v6, v69, v73
    v_bfi_b32 v19, v7, v70, v74
    v_bfi_b32 v20, v8, v71, v75
    v_bfi_b32 v21, v6, v73, v77
    v_bfi_b32 v22, v7, v74, v78
    v_bfi_b32 v23, v8, v75, v79
    v_add_f32_dpp v13, v14, v13 wave_ror:1 row_mask:0xf bank_mask:0xf
    v_add_f32_dpp v16, v17, v16 wave_ror:1 row_mask:0xf bank_mask:0xf
    v_add_f32_dpp v19, v20, v19 wave_ror:1 row_mask:0xf bank_mask:0xf
    v_add_f32_dpp v22, v23, v22 wave_ror:1 row_mask:0xf bank_mask:0xf
    v_add_f32_dpp v12, v13, v12 wave_ror:1 row_mask:0xf bank_mask:0xf
    v_add_f32_dpp v15, v16, v15 wave_ror:1 row_mask:0xf bank_mask:0xf
    v_add_f32_dpp v18, v19, v18 wave_ror:1 row_mask:0xf bank_mask:0xf
    v_add_f32_dpp v21, v22, v21 wave_ror:1 row_mask:0xf bank_mask:0xf
    v_add_f32_dpp v24, v12, v64 wave_ror:1 row_mask:0xf bank_mask:0xf
    v_add_f32_dpp v25, v15, v68 wave_ror:1 row_mask:0xf bank_mask:0xf
    v_add_f32_dpp v26, v18, v72 wave_ror:1 row_mask:0xf bank_mask:0xf
    v_add_f32_dpp v27, v21, v76 wave_ror:1 row_mask:0xf bank_mask:0xf
    v_pk_mul_f32 v[24:25], v[24:25], s[28:29] op_sel_hi:[1,0]
    v_pk_mul_f32 v[26:27], v[26:27], s[28:29] op_sel_hi:[1,0]
    v_cvt_pk_bf16_f32 v24, v24, v25
    v_cvt_pk_bf16_f32 v26, v26, v27
    ds_write_b16 v33, v24 offset:0
    ds_write_b16_d16_hi v33, v24 offset:128
    ds_write_b16 v33, v26 offset:256
    ds_write_b16_d16_hi v33, v26 offset:384
    ds_read_b128 v[36:39], v34
    s_waitcnt lgkmcnt(0)
    buffer_store_dwordx4 v[36:39], v35, s[60:63], s31 offen sc1
    s_branch L_convdone
.p2align 6
L_warmB:
    s_branch L_warmback
    s_nop 0
L_expB:
    ds_read2_b32 v[22:23], v120 offset0:0 offset1:16
    ds_read_b32 v21, v117 offset:16
    ds_read2st64_b32 v[80:81], v113 offset0:4 offset1:5
    ds_read2st64_b32 v[90:91], v113 offset0:123 offset1:124
    ds_read2st64_b32 v[82:83], v113 offset0:8 offset1:9
    ds_read2st64_b32 v[92:93], v113 offset0:127 offset1:128
    s_waitcnt lgkmcnt(13)
    v_mfma_f32_32x32x16_f16 v[64:79], v[160:163], v[128:131], 0
    ds_read2st64_b32 v[84:85], v113 offset0:6 offset1:7
    ds_read2st64_b32 v[94:95], v113 offset0:125 offset1:126
    s_waitcnt lgkmcnt(14)
    v_mfma_f32_32x32x16_f16 v[64:79], v[164:167], v[132:135], v[64:79]
    ds_read2st64_b32 v[86:87], v113 offset0:10 offset1:11
    ds_read2st64_b32 v[96:97], v113 offset0:129 offset1:130
    s_waitcnt lgkmcnt(15)
    v_mfma_f32_32x32x16_f16 v[64:79], v[168:171], v[136:139], v[64:79]
    s_waitcnt lgkmcnt(14)
    v_mfma_f32_32x32x16_f16 v[64:79], v[172:175], v[140:143], v[64:79]
    s_waitcnt lgkmcnt(8)
L_hcB:
    v_min3_u32 v12, v21, v22, v23
    v_max3_u32 v14, v21, v22, v23
    v_cmp_eq_u32 vcc, 0, v12
    s_nop 0
    s_cbranch_vccnz L_hrB
    v_mfma_f32_32x32x16_f16 v[64:79], v[176:179], v[144:147], v[64:79]
    v_max_u32 v14, v14, v19
    v_sub_u32 v22, v22, v14
    v_sub_u32_e64 v23, v23, v14
    v_ldexp_f32 v22, 1.0, v22
    v_mfma_f32_32x32x16_f16 v[64:79], v[180:183], v[148:151], v[64:79]
    s_waitcnt lgkmcnt(0)
    s_nop 0
    v_pk_mul_f32 v[80:81], v[80:81], v[22:23] op_sel_hi:[1,0]
    v_pk_mul_f32 v[82:83], v[82:83], v[22:23] op_sel_hi:[1,0]
    v_pk_mul_f32 v[84:85], v[84:85], v[22:23] op_sel_hi:[1,0]
    v_pk_mul_f32 v[86:87], v[86:87], v[22:23] op_sel_hi:[1,0]
    v_mfma_f32_32x32x16_f16 v[64:79], v[184:187], v[152:155], v[64:79]
    v_ldexp_f32 v23, 1.0, v23
    v_sub_u32 v20, v19, v14
    v_sub_u32 v21, v21, v14
    v_add_u32 v14, -121, v14
    v_mfma_f32_32x32x16_f16 v[64:79], v[188:191], v[156:159], v[64:79]
    v_pk_fma_f32 v[80:81], v[90:91], v[22:23], v[80:81] op_sel:[0,1,0] op_sel_hi:[1,1,1]
    v_pk_fma_f32 v[82:83], v[92:93], v[22:23], v[82:83] op_sel:[0,1,0] op_sel_hi:[1,1,1]
    v_pk_fma_f32 v[84:85], v[94:95], v[22:23], v[84:85] op_sel:[0,1,0] op_sel_hi:[1,1,1]
    v_pk_fma_f32 v[86:87], v[96:97], v[22:23], v[86:87] op_sel:[0,1,0] op_sel_hi:[1,1,1]
    v_ldexp_f32 v18, v105, v14
    v_ldexp_f32 v20, 1.0, v20
    v_ldexp_f32 v21, 1.0, v21
    v_readfirstlane_b32 s28, v18
    s_nop 3
    ds_write_addtid_b32 v64 offset:0
    ds_write_addtid_b32 v65 offset:256
    ds_write_addtid_b32 v66 offset:512
    ds_write_addtid_b32 v67 offset:768
    ds_write_addtid_b32 v74 offset:2560
    ds_write_addtid_b32 v75 offset:2816
    ds_write_b32 v10, v3 offset:28
    ds_read_b32 v12, v117 offset:28
    ds_read2st64_b32 v[100:101], v114 offset0:4 offset1:5
    ds_read2st64_b32 v[102:103], v114 offset0:8 offset1:9
    ds_read2st64_b32 v[104:105], v114 offset0:6 offset1:7
    ds_read2st64_b32 v[106:107], v114 offset0:10 offset1:11
    v_pk_fma_f32 v[68:69], v[68:69], v[20:21], v[80:81] op_sel_hi:[1,0,1]
    v_pk_fma_f32 v[72:73], v[72:73], v[20:21], v[82:83] op_sel_hi:[1,0,1]
    v_pk_fma_f32 v[70:71], v[70:71], v[20:21], v[84:85] op_sel_hi:[1,0,1]
    v_pk_fma_f32 v[74:75], v[74:75], v[20:21], v[86:87] op_sel_hi:[1,0,1]
    s_waitcnt vmcnt(0) lgkmcnt(4)
L_psB:
    v_cmp_eq_u32_e64 vcc, 0, v12
    s_nop 0
    s_cbranch_vccnz L_prB
    s_waitcnt lgkmcnt(0)
    v_pk_fma_f32 v[68:69], v[100:101], v[20:21], v[68:69] op_sel:[0,1,0] op_sel_hi:[1,1,1]
    v_pk_fma_f32 v[72:73], v[102:103], v[20:21], v[72:73] op_sel:[0,1,0] op_sel_hi:[1,1,1]
    v_pk_fma_f32 v[70:71], v[104:105], v[20:21], v[70:71] op_sel:[0,1,0] op_sel_hi:[1,1,1]
    v_pk_fma_f32 v[74:75], v[106:107], v[20:21], v[74:75] op_sel:[0,1,0] op_sel_hi:[1,1,1]
    v_mov_b32_dpp v80, v72 wave_rol:1 row_mask:0xf bank_mask:0xf
    v_cvt_pk_f16_f32 v24, v68, v68
    v_mov_b32_dpp v81, v74 wave_rol:1 row_mask:0xf bank_mask:0xf
    v_mov_b32_dpp v80, v68 wave_shl:1 row_mask:0xf bank_mask:0xf
    v_cvt_pk_f16_f32 v25, v69, v70
    v_mov_b32_dpp v81, v72 wave_shl:1 row_mask:0xf bank_mask:0xf
    v_mov_b32_dpp v71, v80 quad_perm:[0,1,2,3] row_mask:0xc bank_mask:0xf
    v_cvt_pk_f16_f32 v26, v70, v70
    v_cvt_pk_f16_f32 v27, v71, v80
    ds_write_b128 v115, v[24:27] offset:576
    v_bfi_b32 v84, v121, v81, v72
    v_cvt_pk_f16_f32 v85, v73, v73
    v_cvt_pk_f16_f32 v22, v84, v81
    v_cvt_pk_f16_f32 v20, v72, v72
    v_cvt_pk_f16_f32 v21, v72, v73
    v_mov_b32_dpp v22, v85 quad_perm:[0,1,2,3] row_mask:0x3 bank_mask:0xf
    v_cvt_pk_f16_f32 v23, v81, v81
    ds_write_b128 v115, v[20:23] offset:1600
    s_waitcnt lgkmcnt(0)
    s_barrier
    s_setprio 2
.p2align 3
    ds_read_b128 v[40:43], v4 offset:1536
    ds_read_b64_tr_b16 v[128:129], v5 offset:32
    ds_read_b64_tr_b16 v[130:131], v5 offset:0
    ds_read_b128 v[44:47], v4 offset:1408
    ds_read_b64_tr_b16 v[132:133], v5 offset:160
    ds_read_b64_tr_b16 v[134:135], v5 offset:128
    ds_read_b128 v[48:51], v4 offset:1280
    ds_read_b64_tr_b16 v[136:137], v5 offset:288
    ds_read_b64_tr_b16 v[138:139], v5 offset:256
    ds_read_b128 v[52:55], v4 offset:1152
    ds_read_b64_tr_b16 v[140:141], v5 offset:416
    ds_read_b64_tr_b16 v[142:143], v5 offset:384
    ds_read_b128 v[56:59], v4 offset:1024
    ds_read_b64_tr_b16 v[144:145], v5 offset:544
    ds_read_b64_tr_b16 v[146:147], v5 offset:512
    s_waitcnt lgkmcnt(12)
    v_mfma_f32_32x32x16_f16 v[64:79], v[40:43], v[128:131], 0
    ds_read_b128 v[60:63], v4 offset:896
    ds_read_b64_tr_b16 v[148:149], v5 offset:672
    ds_read_b64_tr_b16 v[150:151], v5 offset:640
    s_waitcnt lgkmcnt(12)
    v_mfma_f32_32x32x16_f16 v[64:79], v[44:47], v[132:135], v[64:79]
    ds_read_b128 v[40:43], v4 offset:768
    ds_read_b64_tr_b16 v[152:153], v5 offset:800
    ds_read_b64_tr_b16 v[154:155], v5 offset:768
    s_waitcnt lgkmcnt(12)
    v_mfma_f32_32x32x16_f16 v[64:79], v[48:51], v[136:139], v[64:79]
    ds_read_b128 v[44:47], v4 offset:640
    ds_read_b64_tr_b16 v[156:157], v5 offset:928
    ds_read_b64_tr_b16 v[158:159], v5 offset:896
    s_waitcnt lgkmcnt(9)
    v_mfma_f32_32x32x16_f16 v[64:79], v[52:55], v[140:143], v[64:79]
    ds_read_b128 v[48:51], v4 offset:512
    ds_read_b64_tr_b16 v[160:161], v5 offset:1056
    ds_read_b64_tr_b16 v[162:163], v5 offset:1024
    v_mfma_f32_32x32x16_f16 v[64:79], v[56:59], v[144:147], v[64:79]
    ds_read_b128 v[52:55], v4 offset:384
    ds_read_b64_tr_b16 v[164:165], v5 offset:1184
    ds_read_b64_tr_b16 v[166:167], v5 offset:1152
    s_waitcnt lgkmcnt(9)
    v_mfma_f32_32x32x16_f16 v[64:79], v[60:63], v[148:151], v[64:79]
    ds_read_b128 v[56:59], v4 offset:256
    ds_read_b64_tr_b16 v[168:169], v5 offset:1312
    ds_read_b64_tr_b16 v[170:171], v5 offset:1280
    v_mfma_f32_32x32x16_f16 v[64:79], v[40:43], v[152:155], v[64:79]
    ds_read_b128 v[60:63], v4 offset:128
    ds_read_b64_tr_b16 v[172:173], v5 offset:1440
    ds_read_b64_tr_b16 v[174:175], v5 offset:1408
    s_waitcnt lgkmcnt(9)
    v_mfma_f32_32x32x16_f16 v[64:79], v[44:47], v[156:159], v[64:79]
    ds_read_b128 v[40:43], v4 offset:0
    ds_read_b64_tr_b16 v[176:177], v5 offset:1568
    ds_read_b64_tr_b16 v[178:179], v5 offset:1536
    v_mfma_f32_32x32x16_f16 v[64:79], v[48:51], v[160:163], v[64:79]
    ds_read_b128 v[44:47], v4 offset:2048
    ds_read_b64_tr_b16 v[180:181], v5 offset:1696
    ds_read_b64_tr_b16 v[182:183], v5 offset:1664
    s_waitcnt lgkmcnt(9)
    v_mfma_f32_32x32x16_f16 v[64:79], v[52:55], v[164:167], v[64:79]
    ds_read_b128 v[48:51], v4 offset:1920
    ds_read_b64_tr_b16 v[184:185], v5 offset:1824
    ds_read_b64_tr_b16 v[186:187], v5 offset:1792
    v_mfma_f32_32x32x16_f16 v[64:79], v[56:59], v[168:171], v[64:79]
    ds_read_b128 v[52:55], v4 offset:1792
    ds_read_b64_tr_b16 v[188:189], v5 offset:1952
    ds_read_b64_tr_b16 v[190:191], v5 offset:1920
    s_waitcnt lgkmcnt(9)
    v_mfma_f32_32x32x16_f16 v[64:79], v[60:63], v[172:175], v[64:79]
    ds_read_b128 v[56:59], v4 offset:1664
    ds_read_b64_tr_b16 v[192:193], v5 offset:2080
    ds_read_b64_tr_b16 v[194:195], v5 offset:2048
    v_mfma_f32_32x32x16_f16 v[64:79], v[40:43], v[176:179], v[64:79]
    ds_read_b128 v[60:63], v4 offset:1536
    ds_read_b64_tr_b16 v[196:197], v5 offset:2208
    ds_read_b64_tr_b16 v[198:199], v5 offset:2176
    s_waitcnt lgkmcnt(11)
    v_mfma_f32_32x32x16_f16 v[80:95], v[44:47], v[128:131], 0
    ds_read_b128 v[40:43], v4 offset:1408
    ds_read_b64_tr_b16 v[200:201], v5 offset:2336
    ds_read_b64_tr_b16 v[202:203], v5 offset:2304
    v_mfma_f32_32x32x16_f16 v[80:95], v[48:51], v[132:135], v[80:95]
    ds_read_b128 v[44:47], v4 offset:1280
    ds_read_b64_tr_b16 v[204:205], v5 offset:2464
    ds_read_b64_tr_b16 v[206:207], v5 offset:2432
    s_waitcnt lgkmcnt(11)
    v_mfma_f32_32x32x16_f16 v[80:95], v[52:55], v[136:139], v[80:95]
    ds_read_b128 v[48:51], v4 offset:1152
    v_bfi_b32 v15, v6, v65, v69
    v_bfi_b32 v16, v7, v66, v70
    v_bfi_b32 v17, v8, v67, v71
    v_bfi_b32 v18, v6, v69, v73
    v_mfma_f32_32x32x16_f16 v[80:95], v[56:59], v[140:143], v[80:95]
    ds_read_b128 v[52:55], v4 offset:1024
    v_bfi_b32 v19, v7, v70, v74
    v_bfi_b32 v20, v8, v71, v75
    v_bfi_b32 v21, v6, v73, v77
    s_waitcnt lgkmcnt(7)
    v_mfma_f32_32x32x16_f16 v[80:95], v[60:63], v[144:147], v[80:95]
    ds_read_b128 v[56:59], v4 offset:896
    v_bfi_b32 v22, v7, v74, v78
    v_bfi_b32 v23, v8, v75, v79
    v_add_f32_dpp v13, v67, v66 wave_ror:1 row_mask:0xf bank_mask:0xf
    v_add_f32_dpp v16, v17, v16 wave_ror:1 row_mask:0xf bank_mask:0xf
    v_mfma_f32_32x32x16_f16 v[80:95], v[40:43], v[148:151], v[80:95]
    ds_read_b128 v[60:63], v4 offset:768
    v_add_f32_dpp v19, v20, v19 wave_ror:1 row_mask:0xf bank_mask:0xf
    v_add_f32_dpp v22, v23, v22 wave_ror:1 row_mask:0xf bank_mask:0xf
    v_add_f32_dpp v12, v13, v65 wave_ror:1 row_mask:0xf bank_mask:0xf
    s_waitcnt lgkmcnt(3)
    v_mfma_f32_32x32x16_f16 v[80:95], v[44:47], v[152:155], v[80:95]
    ds_read_b128 v[40:43], v4 offset:640
    v_add_f32_dpp v15, v16, v15 wave_ror:1 row_mask:0xf bank_mask:0xf
    v_add_f32_dpp v18, v19, v18 wave_ror:1 row_mask:0xf bank_mask:0xf
    v_add_f32_dpp v21, v22, v21 wave_ror:1 row_mask:0xf bank_mask:0xf
    v_add_f32_dpp v24, v12, v64 wave_ror:1 row_mask:0xf bank_mask:0xf
    v_mfma_f32_32x32x16_f16 v[80:95], v[48:51], v[156:159], v[80:95]
    ds_read_b128 v[44:47], v4 offset:512
    v_add_f32_dpp v25, v15, v68 wave_ror:1 row_mask:0xf bank_mask:0xf
    v_add_f32_dpp v26, v18, v72 wave_ror:1 row_mask:0xf bank_mask:0xf
    v_add_f32_dpp v27, v21, v76 wave_ror:1 row_mask:0xf bank_mask:0xf
    s_waitcnt lgkmcnt(3)
    v_mfma_f32_32x32x16_f16 v[80:95], v[52:55], v[160:163], v[80:95]
    ds_read_b128 v[48:51], v4 offset:384
    v_mul_f32_e64 v24, s28, v24
    v_mul_f32_e64 v25, s28, v25
    v_mul_f32_e64 v26, s28, v26
    v_mul_f32_e64 v27, s28, v27
    v_mfma_f32_32x32x16_f16 v[80:95], v[56:59], v[164:167], v[80:95]
    ds_read_b128 v[52:55], v4 offset:256
    v_cvt_pk_bf16_f32 v24, v24, v25
    v_cvt_pk_bf16_f32 v26, v26, v27
    s_waitcnt lgkmcnt(3)
    v_mfma_f32_32x32x16_f16 v[80:95], v[60:63], v[168:171], v[80:95]
    ds_read_b128 v[56:59], v4 offset:128
    ds_write_b16 v33, v24 offset:0
    ds_write_b16_d16_hi v33, v24 offset:128
    v_mfma_f32_32x32x16_f16 v[80:95], v[40:43], v[172:175], v[80:95]
    ds_read_b128 v[60:63], v4 offset:0
    ds_write_b16 v33, v26 offset:256
    s_waitcnt lgkmcnt(6)
    v_mfma_f32_32x32x16_f16 v[80:95], v[44:47], v[176:179], v[80:95]
    ds_read_b128 v[40:43], v4 offset:2560
    ds_write_b16_d16_hi v33, v26 offset:384
    ds_read_b128 v[36:39], v34
    v_mfma_f32_32x32x16_f16 v[80:95], v[48:51], v[180:183], v[80:95]
    ds_read_b128 v[44:47], v4 offset:2432
    ds_read_b64_tr_b16 v[208:209], v5 offset:2592
    ds_read_b64_tr_b16 v[210:211], v5 offset:2560
    s_waitcnt lgkmcnt(10)
    v_mfma_f32_32x32x16_f16 v[80:95], v[52:55], v[184:187], v[80:95]
    ds_read_b128 v[48:51], v4 offset:2304
    ds_read_b64_tr_b16 v[212:213], v5 offset:2720
    ds_read_b64_tr_b16 v[214:215], v5 offset:2688
    v_mfma_f32_32x32x16_f16 v[80:95], v[56:59], v[188:191], v[80:95]
    ds_read_b128 v[52:55], v4 offset:2176
    ds_read_b64_tr_b16 v[216:217], v5 offset:2848
    ds_read_b64_tr_b16 v[218:219], v5 offset:2816
    s_waitcnt lgkmcnt(11)
    v_mfma_f32_32x32x16_f16 v[80:95], v[60:63], v[192:195], v[80:95]
    ds_read_b128 v[56:59], v4 offset:2048
    ds_read_b64_tr_b16 v[220:221], v5 offset:2976
    ds_read_b64_tr_b16 v[222:223], v5 offset:2944
    v_mfma_f32_32x32x16_f16 v[96:111], v[40:43], v[128:131], 0
    ds_read_b128 v[60:63], v4 offset:1920
    ds_read_b64_tr_b16 v[224:225], v5 offset:3104
    ds_read_b64_tr_b16 v[226:227], v5 offset:3072
    s_waitcnt lgkmcnt(11)
    v_mfma_f32_32x32x16_f16 v[96:111], v[44:47], v[132:135], v[96:111]
    ds_read_b128 v[40:43], v4 offset:1792
    s_add_u32 s31, s30, 487424
    s_mov_b32 exec_lo, -16
    buffer_store_dwordx4 v[36:39], v35, s[60:63], s31 offen sc1
    s_mov_b32 exec_lo, -1
    v_mfma_f32_32x32x16_f16 v[96:111], v[48:51], v[136:139], v[96:111]
    ds_read_b128 v[44:47], v4 offset:1664
    v_bfi_b32 v12, v6, v77, v81
    v_bfi_b32 v13, v7, v78, v82
    v_bfi_b32 v14, v8, v79, v83
    s_waitcnt lgkmcnt(7)
    v_mfma_f32_32x32x16_f16 v[96:111], v[52:55], v[140:143], v[96:111]
    ds_read_b128 v[48:51], v4 offset:1536
    v_bfi_b32 v15, v6, v81, v85
    v_bfi_b32 v16, v7, v82, v86
    v_bfi_b32 v17, v8, v83, v87
    v_bfi_b32 v18, v6, v85, v89
    v_mfma_f32_32x32x16_f16 v[96:111], v[56:59], v[144:147], v[96:111]
    ds_read_b128 v[52:55], v4 offset:1408
    v_bfi_b32 v19, v7, v86, v90
    v_bfi_b32 v20, v8, v87, v91
    v_bfi_b32 v21, v6, v89, v93
    s_waitcnt lgkmcnt(3)
    v_mfma_f32_32x32x16_f16 v[96:111], v[60:63], v[148:151], v[96:111]
    ds_read_b128 v[56:59], v4 offset:1280
    v_bfi_b32 v22, v7, v90, v94
    v_bfi_b32 v23, v8, v91, v95
    v_add_f32_dpp v13, v14, v13 wave_ror:1 row_mask:0xf bank_mask:0xf
    v_add_f32_dpp v16, v17, v16 wave_ror:1 row_mask:0xf bank_mask:0xf
    v_mfma_f32_32x32x16_f16 v[96:111], v[40:43], v[152:155], v[96:111]
    ds_read_b128 v[60:63], v4 offset:1152
    v_add_f32_dpp v19, v20, v19 wave_ror:1 row_mask:0xf bank_mask:0xf
    v_add_f32_dpp v22, v23, v22 wave_ror:1 row_mask:0xf bank_mask:0xf
    v_add_f32_dpp v12, v13, v12 wave_ror:1 row_mask:0xf bank_mask:0xf
    s_waitcnt lgkmcnt(3)
    v_mfma_f32_32x32x16_f16 v[96:111], v[44:47], v[156:159], v[96:111]
    ds_read_b128 v[40:43], v4 offset:1024
    v_add_f32_dpp v15, v16, v15 wave_ror:1 row_mask:0xf bank_mask:0xf
    v_add_f32_dpp v18, v19, v18 wave_ror:1 row_mask:0xf bank_mask:0xf
    v_add_f32_dpp v21, v22, v21 wave_ror:1 row_mask:0xf bank_mask:0xf
    v_add_f32_dpp v24, v12, v80 wave_ror:1 row_mask:0xf bank_mask:0xf
    v_mfma_f32_32x32x16_f16 v[96:111], v[48:51], v[160:163], v[96:111]
    ds_read_b128 v[44:47], v4 offset:896
    v_add_f32_dpp v25, v15, v84 wave_ror:1 row_mask:0xf bank_mask:0xf
    v_add_f32_dpp v26, v18, v88 wave_ror:1 row_mask:0xf bank_mask:0xf
    v_add_f32_dpp v27, v21, v92 wave_ror:1 row_mask:0xf bank_mask:0xf
    s_waitcnt lgkmcnt(3)
    v_mfma_f32_32x32x16_f16 v[96:111], v[52:55], v[164:167], v[96:111]
    ds_read_b128 v[48:51], v4 offset:768
    v_mul_f32_e64 v24, s28, v24
    v_mul_f32_e64 v25, s28, v25
    v_mul_f32_e64 v26, s28, v26
    v_mul_f32_e64 v27, s28, v27
    v_mfma_f32_32x32x16_f16 v[96:111], v[56:59], v[168:171], v[96:111]
    ds_read_b128 v[52:55], v4 offset:640
    v_cvt_pk_bf16_f32 v24, v24, v25
    v_cvt_pk_bf16_f32 v26, v26, v27
    s_waitcnt lgkmcnt(3)
    v_mfma_f32_32x32x16_f16 v[96:111], v[60:63], v[172:175], v[96:111]
    ds_read_b128 v[56:59], v4 offset:512
    ds_write_b16 v33, v24 offset:0
    ds_write_b16_d16_hi v33, v24 offset:128
    v_mfma_f32_32x32x16_f16 v[96:111], v[40:43], v[176:179], v[96:111]
    ds_read_b128 v[60:63], v4 offset:384
    ds_write_b16 v33, v26 offset:256
    s_waitcnt lgkmcnt(6)
    v_mfma_f32_32x32x16_f16 v[96:111], v[44:47], v[180:183], v[96:111]
    ds_read_b128 v[40:43], v4 offset:256
    ds_write_b16_d16_hi v33, v26 offset:384
    ds_read_b128 v[36:39], v34
    v_mfma_f32_32x32x16_f16 v[96:111], v[48:51], v[184:187], v[96:111]
    ds_read_b128 v[44:47], v4 offset:128
    s_waitcnt lgkmcnt(8)
    v_mfma_f32_32x32x16_f16 v[96:111], v[52:55], v[188:191], v[96:111]
    ds_read_b128 v[48:51], v4 offset:0
    v_mfma_f32_32x32x16_f16 v[96:111], v[56:59], v[192:195], v[96:111]
    ds_read_b128 v[52:55], v4 offset:3072
    s_waitcnt lgkmcnt(5)
    v_mfma_f32_32x32x16_f16 v[96:111], v[60:63], v[196:199], v[96:111]
    ds_read_b128 v[56:59], v4 offset:2944
    v_mfma_f32_32x32x16_f16 v[96:111], v[40:43], v[200:203], v[96:111]
    ds_read_b128 v[60:63], v4 offset:2816
    s_waitcnt lgkmcnt(3)
    v_mfma_f32_32x32x16_f16 v[96:111], v[44:47], v[204:207], v[96:111]
    ds_read_b128 v[40:43], v4 offset:2688
    s_add_u32 s31, s30, 716800
    buffer_store_dwordx4 v[36:39], v35, s[60:63], s31 offen sc1
    v_mfma_f32_32x32x16_f16 v[96:111], v[48:51], v[208:211], v[96:111]
    ds_read_b128 v[44:47], v4 offset:2560
    s_waitcnt lgkmcnt(3)
    v_mfma_f32_32x32x16_f16 v[112:127], v[52:55], v[128:131], 0
    ds_read_b128 v[48:51], v4 offset:2432
    v_mfma_f32_32x32x16_f16 v[112:127], v[56:59], v[132:135], v[112:127]
    ds_read_b128 v[52:55], v4 offset:2304
    s_waitcnt lgkmcnt(3)
    v_mfma_f32_32x32x16_f16 v[112:127], v[60:63], v[136:139], v[112:127]
    ds_read_b128 v[56:59], v4 offset:2176
    s_nop 2
    v_bfi_b32 v12, v6, v93, v97
    v_bfi_b32 v13, v7, v94, v98
    v_bfi_b32 v14, v8, v95, v99
    v_bfi_b32 v15, v6, v97, v101
    v_mfma_f32_32x32x16_f16 v[112:127], v[40:43], v[140:143], v[112:127]
    ds_read_b128 v[60:63], v4 offset:2048
    v_bfi_b32 v16, v7, v98, v102
    v_bfi_b32 v17, v8, v99, v103
    v_bfi_b32 v18, v6, v101, v105
    s_waitcnt lgkmcnt(3)
    v_mfma_f32_32x32x16_f16 v[112:127], v[44:47], v[144:147], v[112:127]
    ds_read_b128 v[40:43], v4 offset:1920
    v_bfi_b32 v19, v7, v102, v106
    v_bfi_b32 v20, v8, v103, v107
    v_bfi_b32 v21, v6, v105, v109
    v_bfi_b32 v22, v7, v106, v110
    v_mfma_f32_32x32x16_f16 v[112:127], v[48:51], v[148:151], v[112:127]
    ds_read_b128 v[44:47], v4 offset:1792
    v_bfi_b32 v23, v8, v107, v111
    v_add_f32_dpp v13, v14, v13 wave_ror:1 row_mask:0xf bank_mask:0xf
    v_add_f32_dpp v16, v17, v16 wave_ror:1 row_mask:0xf bank_mask:0xf
    s_waitcnt lgkmcnt(3)
    v_mfma_f32_32x32x16_f16 v[112:127], v[52:55], v[152:155], v[112:127]
    ds_read_b128 v[48:51], v4 offset:1664
    v_add_f32_dpp v19, v20, v19 wave_ror:1 row_mask:0xf bank_mask:0xf
    v_add_f32_dpp v22, v23, v22 wave_ror:1 row_mask:0xf bank_mask:0xf
    v_add_f32_dpp v12, v13, v12 wave_ror:1 row_mask:0xf bank_mask:0xf
    v_add_f32_dpp v15, v16, v15 wave_ror:1 row_mask:0xf bank_mask:0xf
    v_mfma_f32_32x32x16_f16 v[112:127], v[56:59], v[156:159], v[112:127]
    ds_read_b128 v[52:55], v4 offset:1536
    v_add_f32_dpp v18, v19, v18 wave_ror:1 row_mask:0xf bank_mask:0xf
    v_add_f32_dpp v21, v22, v21 wave_ror:1 row_mask:0xf bank_mask:0xf
    v_add_f32_dpp v24, v12, v96 wave_ror:1 row_mask:0xf bank_mask:0xf
    s_waitcnt lgkmcnt(3)
    v_mfma_f32_32x32x16_f16 v[112:127], v[60:63], v[160:163], v[112:127]
    ds_read_b128 v[56:59], v4 offset:1408
    v_add_f32_dpp v25, v15, v100 wave_ror:1 row_mask:0xf bank_mask:0xf
    v_add_f32_dpp v26, v18, v104 wave_ror:1 row_mask:0xf bank_mask:0xf
    v_add_f32_dpp v27, v21, v108 wave_ror:1 row_mask:0xf bank_mask:0xf
    v_mul_f32_e64 v24, s28, v24
    v_mfma_f32_32x32x16_f16 v[112:127], v[40:43], v[164:167], v[112:127]
    ds_read_b128 v[60:63], v4 offset:1280
    v_mul_f32_e64 v25, s28, v25
    v_mul_f32_e64 v26, s28, v26
    v_mul_f32_e64 v27, s28, v27
    s_waitcnt lgkmcnt(3)
    v_mfma_f32_32x32x16_f16 v[112:127], v[44:47], v[168:171], v[112:127]
    ds_read_b128 v[40:43], v4 offset:1152
    v_cvt_pk_bf16_f32 v24, v24, v25
    v_cvt_pk_bf16_f32 v26, v26, v27
    ds_write_b16 v33, v24 offset:0
    v_mfma_f32_32x32x16_f16 v[112:127], v[48:51], v[172:175], v[112:127]
    ds_read_b128 v[44:47], v4 offset:1024
    ds_write_b16_d16_hi v33, v24 offset:128
    s_waitcnt lgkmcnt(5)
    v_mfma_f32_32x32x16_f16 v[112:127], v[52:55], v[176:179], v[112:127]
    ds_read_b128 v[48:51], v4 offset:896
    ds_write_b16 v33, v26 offset:256
    ds_write_b16_d16_hi v33, v26 offset:384
    v_mfma_f32_32x32x16_f16 v[112:127], v[56:59], v[180:183], v[112:127]
    ds_read_b128 v[52:55], v4 offset:768
    ds_read_b128 v[36:39], v34
    s_waitcnt lgkmcnt(8)
    v_mfma_f32_32x32x16_f16 v[112:127], v[60:63], v[184:187], v[112:127]
    ds_read_b128 v[56:59], v4 offset:640
    v_mfma_f32_32x32x16_f16 v[112:127], v[40:43], v[188:191], v[112:127]
    ds_read_b128 v[60:63], v4 offset:512
    s_waitcnt lgkmcnt(6)
    v_mfma_f32_32x32x16_f16 v[112:127], v[44:47], v[192:195], v[112:127]
    ds_read_b128 v[40:43], v4 offset:384
    v_mfma_f32_32x32x16_f16 v[112:127], v[48:51], v[196:199], v[112:127]
    ds_read_b128 v[44:47], v4 offset:256
    s_waitcnt lgkmcnt(3)
    v_mfma_f32_32x32x16_f16 v[112:127], v[52:55], v[200:203], v[112:127]
    ds_read_b128 v[48:51], v4 offset:128
    s_add_u32 s31, s30, 946176
    buffer_store_dwordx4 v[36:39], v35, s[60:63], s31 offen sc1
    v_mfma_f32_32x32x16_f16 v[112:127], v[56:59], v[204:207], v[112:127]
    ds_read_b128 v[52:55], v4 offset:0
    s_waitcnt lgkmcnt(3)
    v_mfma_f32_32x32x16_f16 v[112:127], v[60:63], v[208:211], v[112:127]
    v_mfma_f32_32x32x16_f16 v[112:127], v[40:43], v[212:215], v[112:127]
    s_waitcnt lgkmcnt(1)
    v_mfma_f32_32x32x16_f16 v[112:127], v[44:47], v[216:219], v[112:127]
    v_mfma_f32_32x32x16_f16 v[112:127], v[48:51], v[220:223], v[112:127]
    s_waitcnt lgkmcnt(0)
    v_mfma_f32_32x32x16_f16 v[112:127], v[52:55], v[224:227], v[112:127]
    s_add_u32 s31, s30, 1175552
    s_nop 10
    v_bfi_b32 v12, v6, v109, v113
    v_bfi_b32 v13, v7, v110, v114
    v_bfi_b32 v14, v8, v111, v115
    v_bfi_b32 v15, v6, v113, v117
    v_bfi_b32 v16, v7, v114, v118
    v_bfi_b32 v17, v8, v115, v119
    v_bfi_b32 v18, v6, v117, v121
    v_bfi_b32 v19, v7, v118, v122
    v_bfi_b32 v20, v8, v119, v123
    v_bfi_b32 v21, v6, v121, v125
    v_bfi_b32 v22, v7, v122, v126
    v_bfi_b32 v23, v8, v123, v127
    v_add_f32_dpp v13, v14, v13 wave_ror:1 row_mask:0xf bank_mask:0xf
    v_add_f32_dpp v16, v17, v16 wave_ror:1 row_mask:0xf bank_mask:0xf
    v_add_f32_dpp v19, v20, v19 wave_ror:1 row_mask:0xf bank_mask:0xf
    v_add_f32_dpp v22, v23, v22 wave_ror:1 row_mask:0xf bank_mask:0xf
    v_add_f32_dpp v12, v13, v12 wave_ror:1 row_mask:0xf bank_mask:0xf
    v_add_f32_dpp v15, v16, v15 wave_ror:1 row_mask:0xf bank_mask:0xf
    v_add_f32_dpp v18, v19, v18 wave_ror:1 row_mask:0xf bank_mask:0xf
    v_add_f32_dpp v21, v22, v21 wave_ror:1 row_mask:0xf bank_mask:0xf
    v_add_f32_dpp v24, v12, v112 wave_ror:1 row_mask:0xf bank_mask:0xf
    v_add_f32_dpp v25, v15, v116 wave_ror:1 row_mask:0xf bank_mask:0xf
    v_add_f32_dpp v26, v18, v120 wave_ror:1 row_mask:0xf bank_mask:0xf
    v_add_f32_dpp v27, v21, v124 wave_ror:1 row_mask:0xf bank_mask:0xf
    v_pk_mul_f32 v[24:25], v[24:25], s[28:29] op_sel_hi:[1,0]
    v_pk_mul_f32 v[26:27], v[26:27], s[28:29] op_sel_hi:[1,0]
    v_cvt_pk_bf16_f32 v24, v24, v25
    v_cvt_pk_bf16_f32 v26, v26, v27
    ds_write_b16 v33, v24 offset:0
    ds_write_b16_d16_hi v33, v24 offset:128
    ds_write_b16 v33, v26 offset:256
    ds_write_b16_d16_hi v33, v26 offset:384
    ds_read_b128 v[36:39], v34
    s_waitcnt lgkmcnt(0)
    buffer_store_dwordx4 v[36:39], v35, s[60:63], s31 offen sc1
L_convdone:
    s_setprio 0
    s_barrier
    s_cmp_lt_u32 s2, 0
    s_cbranch_scc1 L_cp1
    s_cmp_eq_u32 s2, s2
    s_cbranch_scc1 L_cp1
    s_nop 0
    buffer_load_dwordx4 v[60:63], v28, s[60:63], 0 offen sc1
L_cp1:
    ds_read_b64_tr_b16 v[40:41], v31
    ds_read_b64_tr_b16 v[42:43], v31 offset:3840
    ds_read_b64_tr_b16 v[52:53], v31 offset:7680
    ds_read_b64_tr_b16 v[54:55], v31 offset:11520
    s_mov_b32 s14, 0xc238aa3b
    v_mul_f32 v56, 0x44800000, v32
    s_waitcnt lgkmcnt(2)
    s_nop 0
    v_and_b32 v40, 0xbff8bff8, v40
    v_and_b32 v41, 0xbff8bff8, v41
    v_and_b32 v42, 0xbff8bff8, v42
    v_and_b32 v43, 0xbff8bff8, v43
    v_fma_mix_f32 v20, v40, s14, 0 op_sel_hi:[1,0,0]
    v_fma_mix_f32 v21, v40, s14, 0 op_sel:[1,0,0] op_sel_hi:[1,0,0]
    v_fma_mix_f32 v22, v41, s14, 0 op_sel_hi:[1,0,0]
    v_fma_mix_f32 v23, v41, s14, 0 op_sel:[1,0,0] op_sel_hi:[1,0,0]
    v_fma_mix_f32 v24, v42, s14, 0 op_sel_hi:[1,0,0]
    v_fma_mix_f32 v25, v42, s14, 0 op_sel:[1,0,0] op_sel_hi:[1,0,0]
    v_fma_mix_f32 v26, v43, s14, 0 op_sel_hi:[1,0,0]
    v_fma_mix_f32 v27, v43, s14, 0 op_sel:[1,0,0] op_sel_hi:[1,0,0]
    v_exp_f32 v20, v20
    v_exp_f32 v21, v21
    v_exp_f32 v22, v22
    v_exp_f32 v23, v23
    v_exp_f32 v24, v24
    v_exp_f32 v25, v25
    v_exp_f32 v26, v26
    v_exp_f32 v27, v27
    v_pk_add_f32 v[20:21], v[20:21], 1.0 op_sel_hi:[1,0]
    v_pk_add_f32 v[22:23], v[22:23], 1.0 op_sel_hi:[1,0]
    v_pk_add_f32 v[24:25], v[24:25], 1.0 op_sel_hi:[1,0]
    v_pk_add_f32 v[26:27], v[26:27], 1.0 op_sel_hi:[1,0]
    v_rcp_f32 v20, v20
    v_rcp_f32 v21, v21
    v_rcp_f32 v22, v22
    v_rcp_f32 v23, v23
    v_rcp_f32 v24, v24
    v_rcp_f32 v25, v25
    v_rcp_f32 v26, v26
    v_rcp_f32 v27, v27
    s_waitcnt lgkmcnt(0)
    v_lshlrev_b32 v12, 16, v52
    v_and_b32 v13, 0xffff0000, v52
    v_lshlrev_b32_e64 v14, 16, v53
    v_and_b32 v15, 0xffff0000, v53
    v_lshlrev_b32_e64 v16, 16, v54
    v_and_b32 v17, 0xffff0000, v54
    v_lshlrev_b32_e64 v18, 16, v55
    v_and_b32 v19, 0xffff0000, v55
    v_fma_mix_f32 v44, v40, v56, 0 op_sel_hi:[1,0,0]
    v_fma_mix_f32 v45, v40, v56, 0 op_sel:[1,0,0] op_sel_hi:[1,0,0]
    v_fma_mix_f32 v46, v41, v56, 0 op_sel_hi:[1,0,0]
    v_fma_mix_f32 v47, v41, v56, 0 op_sel:[1,0,0] op_sel_hi:[1,0,0]
    v_fma_mix_f32 v48, v42, v56, 0 op_sel_hi:[1,0,0]
    v_fma_mix_f32 v49, v42, v56, 0 op_sel:[1,0,0] op_sel_hi:[1,0,0]
    v_fma_mix_f32 v50, v43, v56, 0 op_sel_hi:[1,0,0]
    v_fma_mix_f32 v51, v43, v56, 0 op_sel:[1,0,0] op_sel_hi:[1,0,0]
    v_fma_mix_f32 v20, v40, v20, 0 op_sel_hi:[1,0,0]
    v_fma_mix_f32 v21, v40, v21, 0 op_sel:[1,0,0] op_sel_hi:[1,0,0]
    v_fma_mix_f32 v22, v41, v22, 0 op_sel_hi:[1,0,0]
    v_fma_mix_f32 v23, v41, v23, 0 op_sel:[1,0,0] op_sel_hi:[1,0,0]
    v_fma_mix_f32 v24, v42, v24, 0 op_sel_hi:[1,0,0]
    v_fma_mix_f32 v25, v42, v25, 0 op_sel:[1,0,0] op_sel_hi:[1,0,0]
    v_fma_mix_f32 v26, v43, v26, 0 op_sel_hi:[1,0,0]
    v_fma_mix_f32 v27, v43, v27, 0 op_sel:[1,0,0] op_sel_hi:[1,0,0]
    v_pk_fma_f32 v[12:13], v[44:45], v[20:21], v[12:13]
    v_pk_fma_f32 v[14:15], v[46:47], v[22:23], v[14:15]
    v_pk_fma_f32 v[16:17], v[48:49], v[24:25], v[16:17]
    v_pk_fma_f32 v[18:19], v[50:51], v[26:27], v[18:19]
    s_cmp_eq_u32 s2, s2
    s_cbranch_scc0 L_yld2
    s_sleep 4
    s_branch L_yld
L_help:
    v_bfe_u32 v12, v0, 1, 7
    v_and_b32 v7, 1, v0
    s_lshr_b32 s12, s51, 2
    s_lshl_b32 s12, s12, 15
    s_and_b32 s13, s51, 3
    s_lshl_b32 s13, s13, 5
    s_add_u32 s12, s12, s13
    s_add_u32 s12, s12, 0x50000
    s_waitcnt lgkmcnt(7)
    s_nop 0
    v_mfma_f32_32x32x16_f16 v[64:79], v[160:163], v[128:131], 0
    v_lshl_add_u32 v4, v7, 4, s12
    v_lshl_add_u32 v4, v12, 7, v4
    v_add_u32 v5, 16384, v4
    s_waitcnt lgkmcnt(6)
    v_mfma_f32_32x32x16_f16 v[64:79], v[164:167], v[132:135], v[64:79]
    s_waitcnt lgkmcnt(0)
    v_mfma_f32_32x32x16_f16 v[64:79], v[168:171], v[136:139], v[64:79]
    v_mul_u32_u24 v7, 4672, v7
    v_lshl_add_u32 v7, v12, 4, v7
    v_add_u32 v7, 122368, v7
    v_mfma_f32_32x32x16_f16 v[64:79], v[172:175], v[140:143], v[64:79]
    s_mul_i32 s10, s6, 4672
    s_add_u32 s10, s10, 121856
    v_lshl_add_u32 v8, v1, 3, s10
    v_mfma_f32_32x32x16_f16 v[64:79], v[176:179], v[144:147], v[64:79]
    v_mov_b32 v24, 0
    v_mov_b32 v25, 0
    ds_write_b64 v8, v[24:25]
    v_mfma_f32_32x32x16_f16 v[64:79], v[180:183], v[148:151], v[64:79]
    v_add_u32 v8, 155136, v91
    s_and_b32 s72, s68, 0x40074007
    s_and_b32 s73, s69, 0x40074007
    v_mfma_f32_32x32x16_f16 v[64:79], v[184:187], v[152:155], v[64:79]
    s_and_b32 s74, s70, 0x40074007
    s_and_b32 s75, s71, 0x40074007
    v_mfma_f32_32x32x16_f16 v[64:79], v[188:191], v[156:159], v[64:79]
    s_nop 11
    s_nop 0
    ds_write_addtid_b32 v64 offset:0
    ds_write_addtid_b32 v65 offset:256
    ds_write_addtid_b32 v66 offset:512
    ds_write_addtid_b32 v67 offset:768
    ds_write_addtid_b32 v68 offset:1024
    ds_write_addtid_b32 v69 offset:1280
    ds_write_addtid_b32 v70 offset:1536
    ds_write_addtid_b32 v71 offset:1792
    ds_write_addtid_b32 v72 offset:2048
    ds_write_addtid_b32 v73 offset:2304
    ds_write_addtid_b32 v74 offset:2560
    ds_write_addtid_b32 v75 offset:2816
    ds_write_b32 v10, v19 offset:28
    s_setprio 0
    v_mov_b32 v119, 0x1000
    v_mov_b32 v122, 154952
    v_mov_b32_e64 v118, s34
    s_cmp_eq_u32 s3, 7
    s_cbranch_scc1 L_warmB
    s_waitcnt vmcnt(1)
L_flP:
    ds_read_b32 v68, v8
    s_waitcnt lgkmcnt(0)
    v_cmp_eq_u32_e64 vcc, 0, v68
    s_nop 0
    s_and_b32 s12, vcc_lo, 0x20202020
    s_cbranch_scc1 L_flP
    s_nop 0
    ds_read_b64_tr_b16 v[40:41], v31
    ds_read_b64_tr_b16 v[42:43], v31 offset:3840
    ds_read_b64_tr_b16 v[52:53], v31 offset:7680
    ds_read_b64_tr_b16 v[54:55], v31 offset:11520
    s_mov_b32 s14, 0xc238aa3b
    v_mul_f32 v56, 0x44800000, v32
    s_waitcnt lgkmcnt(2)
    s_nop 0
    v_and_b32 v40, 0xbff8bff8, v40
    v_and_b32 v41, 0xbff8bff8, v41
    v_and_b32 v42, 0xbff8bff8, v42
    v_and_b32 v43, 0xbff8bff8, v43
    v_fma_mix_f32 v20, v40, s14, 0 op_sel_hi:[1,0,0]
    buffer_load_dwordx4 v[96:99], v4, s[60:63], 0 offen sc1
    buffer_load_dwordx4 v[100:103], v5, s[60:63], 0 offen sc1
    v_fma_mix_f32 v21, v40, s14, 0 op_sel:[1,0,0] op_sel_hi:[1,0,0]
    v_fma_mix_f32 v22, v41, s14, 0 op_sel_hi:[1,0,0]
    v_fma_mix_f32 v23, v41, s14, 0 op_sel:[1,0,0] op_sel_hi:[1,0,0]
    v_fma_mix_f32 v24, v42, s14, 0 op_sel_hi:[1,0,0]
    v_fma_mix_f32 v25, v42, s14, 0 op_sel:[1,0,0] op_sel_hi:[1,0,0]
    v_fma_mix_f32 v26, v43, s14, 0 op_sel_hi:[1,0,0]
    v_fma_mix_f32 v27, v43, s14, 0 op_sel:[1,0,0] op_sel_hi:[1,0,0]
    v_exp_f32 v20, v20
    v_exp_f32 v21, v21
    v_exp_f32 v22, v22
    v_exp_f32 v23, v23
    v_exp_f32 v24, v24
    v_exp_f32 v25, v25
    v_exp_f32 v26, v26
    v_exp_f32 v27, v27
    v_pk_add_f32 v[20:21], v[20:21], 1.0 op_sel_hi:[1,0]
    v_pk_add_f32 v[22:23], v[22:23], 1.0 op_sel_hi:[1,0]
    v_pk_add_f32 v[24:25], v[24:25], 1.0 op_sel_hi:[1,0]
    v_pk_add_f32 v[26:27], v[26:27], 1.0 op_sel_hi:[1,0]
    v_rcp_f32 v20, v20
    v_rcp_f32 v21, v21
    v_rcp_f32 v22, v22
    v_rcp_f32 v23, v23
    v_rcp_f32 v24, v24
    v_rcp_f32 v25, v25
    v_rcp_f32 v26, v26
    v_rcp_f32 v27, v27
    s_waitcnt lgkmcnt(0)
    v_lshlrev_b32 v12, 16, v52
    v_and_b32 v13, 0xffff0000, v52
    v_lshlrev_b32_e64 v14, 16, v53
    v_and_b32 v15, 0xffff0000, v53
    v_lshlrev_b32_e64 v16, 16, v54
    v_and_b32 v17, 0xffff0000, v54
    v_lshlrev_b32_e64 v18, 16, v55
    v_and_b32 v19, 0xffff0000, v55
    v_fma_mix_f32 v44, v40, v56, 0 op_sel_hi:[1,0,0]
    v_fma_mix_f32 v45, v40, v56, 0 op_sel:[1,0,0] op_sel_hi:[1,0,0]
    v_fma_mix_f32 v46, v41, v56, 0 op_sel_hi:[1,0,0]
    v_fma_mix_f32 v47, v41, v56, 0 op_sel:[1,0,0] op_sel_hi:[1,0,0]
    v_fma_mix_f32 v48, v42, v56, 0 op_sel_hi:[1,0,0]
    v_fma_mix_f32 v49, v42, v56, 0 op_sel:[1,0,0] op_sel_hi:[1,0,0]
    v_fma_mix_f32 v50, v43, v56, 0 op_sel_hi:[1,0,0]
    v_fma_mix_f32 v51, v43, v56, 0 op_sel:[1,0,0] op_sel_hi:[1,0,0]
    v_fma_mix_f32 v20, v40, v20, 0 op_sel_hi:[1,0,0]
    v_fma_mix_f32 v21, v40, v21, 0 op_sel:[1,0,0] op_sel_hi:[1,0,0]
    v_fma_mix_f32 v22, v41, v22, 0 op_sel_hi:[1,0,0]
    v_fma_mix_f32 v23, v41, v23, 0 op_sel:[1,0,0] op_sel_hi:[1,0,0]
    v_fma_mix_f32 v24, v42, v24, 0 op_sel_hi:[1,0,0]
    v_fma_mix_f32 v25, v42, v25, 0 op_sel:[1,0,0] op_sel_hi:[1,0,0]
    v_fma_mix_f32 v26, v43, v26, 0 op_sel_hi:[1,0,0]
    v_fma_mix_f32 v27, v43, v27, 0 op_sel:[1,0,0] op_sel_hi:[1,0,0]
    v_pk_fma_f32 v[12:13], v[44:45], v[20:21], v[12:13]
    v_pk_fma_f32 v[14:15], v[46:47], v[22:23], v[14:15]
    v_pk_fma_f32 v[16:17], v[48:49], v[24:25], v[16:17]
    v_pk_fma_f32 v[18:19], v[50:51], v[26:27], v[18:19]
    s_branch L_hp1
L_warmback:
    buffer_load_dwordx4 v[96:99], v4, s[60:63], 0 offen sc1
    buffer_load_dwordx4 v[100:103], v5, s[60:63], 0 offen sc1
L_hp1:
    s_setprio 3
    s_mov_b32 s9, 0
L_uchk:
    s_waitcnt vmcnt(0)
    v_xor_b32 v80, s72, v96
    v_xor_b32 v81, s73, v97
    v_xor_b32 v82, s74, v98
    v_xor_b32 v83, s75, v99
    v_xor_b32 v84, s72, v100
    v_xor_b32 v85, s73, v101
    v_xor_b32 v86, s74, v102
    v_xor_b32 v87, s75, v103
    v_or3_b32 v56, v80, v81, v82
    v_or3_b32 v57, v83, v84, v85
    v_or3_b32 v56, v56, v86, v87
    v_or_b32 v56, v56, v57
    v_and_b32 v56, v3, v56
    v_cmp_ne_u32_e64 vcc, 0, v56
    s_add_u32 s9, s9, 1
    s_cbranch_vccz L_uok
    s_cmp_gt_u32 s9, 400000
    s_cbranch_scc1 L_uok
    s_mov_b64 exec, vcc
    buffer_load_dwordx4 v[96:99], v4, s[60:63], 0 offen sc1
    buffer_load_dwordx4 v[100:103], v5, s[60:63], 0 offen sc1
    s_mov_b64 exec, -1
    s_branch L_uchk
L_uok:
    ds_write_b128 v7, v[80:83]
    ds_write_b128 v7, v[84:87] offset:2048
    s_mov_b32 s83, s9
    s_waitcnt lgkmcnt(0)
    s_barrier
    global_load_dword v2, v118, s[44:45]
    s_cmp_lg_u32 s3, 7
    s_cbranch_scc1 L_hw
    s_sleep 32
    buffer_load_dwordx2 v[120:121], v119, s[60:63], 0 offen sc1
    s_barrier
    s_branch L_wchkh
L_hw:
    s_cmp_ge_u32 s2, 0
    s_cbranch_scc1 L_hw1
    s_sleep 36
    buffer_load_dwordx4 v[60:63], v28, s[60:63], 0 offen sc1
    s_barrier
    s_branch L_yld2
L_hw1:
    s_cmp_eq_u32 s2, s2
    s_barrier
    s_cbranch_scc0 L_yld
    s_sleep 9
L_yld:
    buffer_load_dwordx4 v[60:63], v28, s[60:63], 0 offen sc1
L_yld2:
    v_mov_b32 v40, 154952
    s_mov_b64 s[64:65], s[44:45]
    s_mov_b64 s[66:67], s[54:55]
    s_mov_b32 s9, 0
L_bspin:
    ds_read_b32 v59, v40 offset:208
    ds_read_b32 v58, v40
    s_waitcnt lgkmcnt(0)
    v_cmp_eq_u32 vcc, 0, v59
    s_nop 0
    s_cbranch_vccz L_bok
    s_sleep 2
    s_branch L_bspin
L_bok:
    v_readfirstlane_b32 s8, v58
    s_nop 0
    s_andn2_b32 s8, 0x7ff, s8
    s_mul_i32 s8, s8, 896
    s_add_u32 s16, s34, 0
    s_cmp_eq_u32 s16, s8
    s_cselect_b32 s16, s54, s16
    s_add_u32 s17, s34, 3584
    s_cmp_eq_u32 s17, s8
    s_cselect_b32 s17, s54, s17
    s_add_u32 s18, s34, 7168
    s_cmp_eq_u32 s18, s8
    s_cselect_b32 s18, s54, s18
    s_add_u32 s19, s34, 10752
    s_cmp_eq_u32 s19, s8
    s_cselect_b32 s19, s54, s19
    s_add_u32 s20, s34, 14336
    s_cmp_eq_u32 s20, s8
    s_cselect_b32 s20, s54, s20
    s_add_u32 s21, s34, 17920
    s_cmp_eq_u32 s21, s8
    s_cselect_b32 s21, s54, s21
    s_add_u32 s22, s34, 21504
    s_cmp_eq_u32 s22, s8
    s_cselect_b32 s22, s54, s22
    s_add_u32 s23, s34, 25088
    s_cmp_eq_u32 s23, s8
    s_cselect_b32 s23, s54, s23
    s_cmp_lt_u32 s2, 0
    s_cselect_b32 s15, s3, 4
    s_cmp_lt_u32 s15, 4
    s_cbranch_scc0 L_ychk
    s_waitcnt vmcnt(1)
    s_branch L_ychk2
L_ychk:
    s_waitcnt vmcnt(0)
L_ychk2:
    v_max3_u32 v58, v60, v61, v62
    v_lshlrev_b32 v44, 16, v60
    v_max_u32 v58, v58, v63
    v_and_b32 v45, 0xffff0000, v60
    v_cmp_eq_u32 vcc, -1, v58
    v_lshlrev_b32_e64 v46, 16, v61
    s_cbranch_vccnz L_yretry
L_yok:
    v_pk_fma_f32 v[12:13], v[44:45], v[20:21], v[12:13]
    v_and_b32 v47, 0xffff0000, v61
    v_cvt_pk_bf16_f32 v12, v12, v13
    v_pk_fma_f32 v[14:15], v[46:47], v[22:23], v[14:15]
    v_lshlrev_b32_e64 v48, 16, v62
    v_and_b32 v49, 0xffff0000, v62
    v_cvt_pk_bf16_f32 v14, v14, v15
    buffer_store_short v12, v29, s[64:67], s16 offen sc1
    buffer_store_short_d16_hi v12, v29, s[64:67], s17 offen sc1
    buffer_store_short v14, v29, s[64:67], s18 offen sc1
    buffer_store_short_d16_hi v14, v29, s[64:67], s19 offen sc1
    v_pk_fma_f32 v[16:17], v[48:49], v[24:25], v[16:17]
    v_lshlrev_b32_e64 v50, 16, v63
    v_and_b32 v51, 0xffff0000, v63
    v_cvt_pk_bf16_f32 v16, v16, v17
    v_pk_fma_f32 v[18:19], v[50:51], v[26:27], v[18:19]
    s_nop 0
    s_nop 0
    v_cvt_pk_bf16_f32 v18, v18, v19
    buffer_store_short v16, v29, s[64:67], s20 offen sc1
    buffer_store_short_d16_hi v16, v29, s[64:67], s21 offen sc1
    buffer_store_short v18, v29, s[64:67], s22 offen sc1
    buffer_store_short_d16_hi v18, v29, s[64:67], s23 offen sc1
L_fin:
L_end:
    s_endpgm
L_hrA:
    s_sleep 1
    ds_read2_b32 v[22:23], v120 offset0:0 offset1:16
    ds_read_b32 v21, v117 offset:16
    ds_read2st64_b32 v[80:81], v113 offset0:0 offset1:1
    ds_read2st64_b32 v[90:91], v113 offset0:119 offset1:120
    ds_read2st64_b32 v[82:83], v113 offset0:2 offset1:3
    ds_read2st64_b32 v[92:93], v113 offset0:121 offset1:122
    ds_read2st64_b32 v[84:85], v113 offset0:10 offset1:11
    ds_read2st64_b32 v[94:95], v113 offset0:129 offset1:130
    s_waitcnt lgkmcnt(0)
    s_branch L_hcA
L_prA:
    ds_read_b32 v12, v117 offset:28
    ds_read2st64_b32 v[100:101], v114 offset0:0 offset1:1
    ds_read2st64_b32 v[102:103], v114 offset0:2 offset1:3
    ds_read2st64_b32 v[104:105], v114 offset0:10 offset1:11
    s_waitcnt lgkmcnt(3)
    s_branch L_psA
L_hrB:
    s_sleep 1
    s_nop 0
    ds_read2_b32 v[22:23], v120 offset0:0 offset1:16
    ds_read_b32 v21, v117 offset:16
    ds_read2st64_b32 v[80:81], v113 offset0:4 offset1:5
    ds_read2st64_b32 v[90:91], v113 offset0:123 offset1:124
    ds_read2st64_b32 v[82:83], v113 offset0:8 offset1:9
    ds_read2st64_b32 v[92:93], v113 offset0:127 offset1:128
    ds_read2st64_b32 v[84:85], v113 offset0:6 offset1:7
    ds_read2st64_b32 v[94:95], v113 offset0:125 offset1:126
    ds_read2st64_b32 v[86:87], v113 offset0:10 offset1:11
    ds_read2st64_b32 v[96:97], v113 offset0:129 offset1:130
    s_waitcnt lgkmcnt(0)
    s_branch L_hcB
L_prB:
    ds_read_b32 v12, v117 offset:28
    ds_read2st64_b32 v[100:101], v114 offset0:4 offset1:5
    ds_read2st64_b32 v[102:103], v114 offset0:8 offset1:9
    ds_read2st64_b32 v[104:105], v114 offset0:6 offset1:7
    ds_read2st64_b32 v[106:107], v114 offset0:10 offset1:11
    s_waitcnt lgkmcnt(4)
    s_branch L_psB
L_yretry:
    s_add_u32 s9, s9, 1
    s_cmp_gt_u32 s9, 400000
    s_cbranch_scc1 L_yok
    s_mov_b64 exec, vcc
    buffer_load_dwordx4 v[60:63], v28, s[60:63], 0 offen sc1
    s_mov_b64 exec, -1
    s_branch L_ychk
L_win:
    v_mov_b32 v119, 0x1000
    v_mov_b32 v122, 154952
    s_mov_b32 s9, 0
    buffer_load_dwordx2 v[120:121], v119, s[60:63], 0 offen sc1
L_wchkh:
    s_waitcnt vmcnt(0)
L_wchk2h:
    v_cmp_eq_u32 vcc, s69, v121
    s_add_u32 s9, s9, 1
    s_cbranch_vccnz L_wokh
    s_cmp_gt_u32 s9, 400000
    s_cbranch_scc1 L_wokh
    s_sleep 4
    buffer_load_dwordx2 v[120:121], v119, s[60:63], 0 offen sc1
    s_branch L_wchkh
L_wokh:
    ds_write_b32 v122, v120
    ds_write_b32 v122, v3 offset:208
    s_waitcnt lgkmcnt(0)
    s_branch L_fin
L_pub3:
    s_nop 0
    ds_read_b32 v12, v92
    ds_read_b128 v[64:67], v98
    ds_read_b128 v[68:71], v98 offset:16
    ds_read_b64_tr_b16 v[20:21], v31
    ds_read_b64_tr_b16 v[22:23], v31 offset:3840
    s_waitcnt lgkmcnt(4)
    v_cmp_eq_u32_e64 vcc, 0, v12
    s_nop 0
    s_and_b64 s[10:11], vcc, s[12:13]
    s_cbranch_scc1 L_pub3
    s_movk_i32 s14, 960
    s_waitcnt lgkmcnt(2)
    v_max3_u32 v64, v64, v65, v66
    v_max3_u32 v68, v68, v69, v70
    v_max3_u32 v72, v64, v67, v68
    s_waitcnt lgkmcnt(0)
    buffer_store_dwordx4 v[20:23], v39, s[60:63], s9 offen sc1
    v_max_u32 v72, v72, v71
    v_mov_b32 v73, s69
    v_not_b32 v64, v72
    v_bfe_u32 v64, v64, 2, 3
    v_mad_u32_u24 v64, v64, s14, v99
    ds_read_b128 v[24:27], v64
    s_lshl3_add_u32 s10, s50, 0x2000
    s_mov_b64 exec, 1
    buffer_store_dwordx2 v[72:73], v11, s[60:63], s10 offen sc1
    s_mov_b64 exec, -1
    s_cmp_lt_u32 s2, 224
    s_cbranch_scc1 L_pub
L_best:
    s_lshl_b32 s10, s50, 10
    s_add_u32 s10, s10, 0x10000
    s_waitcnt lgkmcnt(0)
    s_nop 0
    v_bfi_b32 v24, v3, s68, v24
    v_bfi_b32 v25, v3, s69, v25
    v_bfi_b32 v26, v3, s70, v26
    v_bfi_b32 v27, v3, s71, v27
    buffer_store_dwordx4 v[24:27], v11, s[60:63], s10 offen sc1
    s_cmp_lt_u32 s2, 224
    s_cbranch_scc1 L_nohf
    s_branch L_pubx
L_fha:
    v_lshrrev_b32_e64 v16, 3, v1
    v_mul_u32_u24 v16, 3584, v16
    v_bfe_u32 v17, v1, 4, 1
    v_and_b32 v18, 7, v1
    v_xor_b32 v17, v17, v18
    v_lshl_add_u32 v124, v17, 4, v16
    v_xor_b32 v125, 32, v124
    v_xor_b32 v126, 64, v124
    v_xor_b32 v127, 0x60, v124
    s_sub_u32 s65, s3, 4
    s_mul_i32 s65, s65, 5
    s_cmp_eq_u32 s3, 7
    s_cselect_b32 s66, 1, 5
    s_mul_i32 s64, s65, 57344
    s_lshl_b32 s13, s2, 7
    s_add_u32 s64, s64, s13
    s_sub_u32 s64, s64, 28672
    s_lshl_b32 s65, s65, 11
    s_branch L_pro0
L_fhb:
    v_lshrrev_b32_e64 v16, 3, v1
    v_mul_u32_u24 v16, 3584, v16
    v_bfe_u32 v17, v1, 4, 1
    v_and_b32 v18, 7, v1
    v_xor_b32 v17, v17, v18
    v_lshl_add_u32 v124, v17, 4, v16
    v_xor_b32 v125, 32, v124
    v_xor_b32 v126, 64, v124
    v_xor_b32 v127, 0x60, v124
    s_mov_b64 s[80:81], s[38:39]
    s_mov_b64 s[16:17], s[40:41]
    s_mov_b64 s[20:21], s[42:43]
    s_cmp_ge_u32 s2, 252
    s_cselect_b32 s82, 0, 1605632
    s_mov_b32 s83, 0x20000
    s_mov_b64 s[18:19], s[82:83]
    s_mov_b64 s[22:23], s[82:83]
    s_mov_b32 m0, s65
    s_add_u32 s100, s64, 28672
    buffer_load_dwordx4 v124, s[80:83], s64 offen lds
    s_add_u32 m0, s65, 1024
    s_nop 0
    buffer_load_dwordx4 v125, s[80:83], s100 offen lds
    s_add_u32 m0, s65, 57344
    s_nop 0
    buffer_load_dwordx4 v126, s[16:19], s64 offen lds
    s_add_u32 m0, s65, 58368
    s_nop 0
    buffer_load_dwordx4 v127, s[16:19], s100 offen lds
    s_add_u32 s64, s64, 57344
    s_add_u32 s65, s65, 2048
    s_sub_u32 s66, s66, 1
    s_branch L_pro2
L_hpro_other:
    s_add_i32 s6, s2, -224
    s_mov_b32 s9, 0
    s_waitcnt lgkmcnt(0)
    s_add_u32 s68, s68, 1
    s_add_u32 s69, s69, 1
    s_add_u32 s70, s70, 1
    s_add_u32 s71, s71, 1
    s_cmp_lt_u32 s2, 252
    s_cbranch_scc1 L_fh2
    s_waitcnt vmcnt(5)
    ds_write_b32 v10, v3 offset:20
    s_branch L_lno
L_fh2:
    s_mov_b64 s[80:81], s[38:39]
    s_mov_b64 s[16:17], s[40:41]
    s_mov_b64 s[20:21], s[42:43]
    s_cmp_ge_u32 s2, 252
    s_cselect_b32 s82, 0, 1605632
    s_mov_b32 s83, 0x20000
    s_mov_b64 s[18:19], s[82:83]
    s_mov_b64 s[22:23], s[82:83]
    v_lshrrev_b32 v16, 3, v1
    v_mul_u32_u24 v16, 3584, v16
    v_bfe_u32 v17, v1, 4, 1
    v_and_b32 v18, 7, v1
    v_xor_b32 v17, v17, v18
    v_lshl_add_u32 v124, v17, 4, v16
    v_xor_b32 v125, 32, v124
    v_xor_b32 v126, 64, v124
    v_xor_b32 v127, 0x60, v124
    s_branch L_fsetup
L_other:
    s_setprio 0
    s_add_i32 s6, s2, -224
    s_mov_b32 s9, 0
    s_cmp_ge_u32 s2, 252
    s_cbranch_scc0 L_ffn
L_lno:
    s_waitcnt vmcnt(0)
    s_sleep 30
    s_cmp_eq_u32 s3, 7
    s_cbranch_scc1 L_win
    v_mov_b32 v8, 155160
L_flL:
    s_sleep 4
    ds_read_b32 v68, v8
    s_waitcnt lgkmcnt(0)
    v_cmp_eq_u32 vcc, 0, v68
    s_nop 0
    s_and_b32 s12, vcc_lo, 1
    s_cbranch_scc1 L_flL
L_sent0:
    s_cmp_eq_u32 s3, 4
    s_cbranch_scc1 L_sent2
    ds_read_b64_tr_b16 v[40:41], v31
    ds_read_b64_tr_b16 v[42:43], v31 offset:3840
    ds_read_b64_tr_b16 v[52:53], v31 offset:7680
    ds_read_b64_tr_b16 v[54:55], v31 offset:11520
    s_mov_b32 s14, 0xc238aa3b
    v_mul_f32 v56, 0x44800000, v32
    s_waitcnt lgkmcnt(2)
    s_nop 0
    v_and_b32 v40, 0xbff8bff8, v40
    v_and_b32 v41, 0xbff8bff8, v41
    v_and_b32 v42, 0xbff8bff8, v42
    v_and_b32 v43, 0xbff8bff8, v43
    v_fma_mix_f32 v20, v40, s14, 0 op_sel_hi:[1,0,0]
    v_fma_mix_f32 v21, v40, s14, 0 op_sel:[1,0,0] op_sel_hi:[1,0,0]
    v_fma_mix_f32 v22, v41, s14, 0 op_sel_hi:[1,0,0]
    v_fma_mix_f32 v23, v41, s14, 0 op_sel:[1,0,0] op_sel_hi:[1,0,0]
    v_fma_mix_f32 v24, v42, s14, 0 op_sel_hi:[1,0,0]
    v_fma_mix_f32 v25, v42, s14, 0 op_sel:[1,0,0] op_sel_hi:[1,0,0]
    v_fma_mix_f32 v26, v43, s14, 0 op_sel_hi:[1,0,0]
    v_fma_mix_f32 v27, v43, s14, 0 op_sel:[1,0,0] op_sel_hi:[1,0,0]
    v_exp_f32 v20, v20
    v_exp_f32 v21, v21
    v_exp_f32 v22, v22
    v_exp_f32 v23, v23
    v_exp_f32 v24, v24
    v_exp_f32 v25, v25
    v_exp_f32 v26, v26
    v_exp_f32 v27, v27
    v_pk_add_f32 v[20:21], v[20:21], 1.0 op_sel_hi:[1,0]
    v_pk_add_f32 v[22:23], v[22:23], 1.0 op_sel_hi:[1,0]
    v_pk_add_f32 v[24:25], v[24:25], 1.0 op_sel_hi:[1,0]
    v_pk_add_f32 v[26:27], v[26:27], 1.0 op_sel_hi:[1,0]
    v_rcp_f32 v20, v20
    v_rcp_f32 v21, v21
    v_rcp_f32 v22, v22
    v_rcp_f32 v23, v23
    v_rcp_f32 v24, v24
    v_rcp_f32 v25, v25
    v_rcp_f32 v26, v26
    v_rcp_f32 v27, v27
    s_waitcnt lgkmcnt(0)
    v_lshlrev_b32 v12, 16, v52
    v_and_b32 v13, 0xffff0000, v52
    v_lshlrev_b32_e64 v14, 16, v53
    v_and_b32 v15, 0xffff0000, v53
    v_lshlrev_b32_e64 v16, 16, v54
    v_and_b32 v17, 0xffff0000, v54
    v_lshlrev_b32_e64 v18, 16, v55
    v_and_b32 v19, 0xffff0000, v55
    v_fma_mix_f32 v44, v40, v56, 0 op_sel_hi:[1,0,0]
    v_fma_mix_f32 v45, v40, v56, 0 op_sel:[1,0,0] op_sel_hi:[1,0,0]
    v_fma_mix_f32 v46, v41, v56, 0 op_sel_hi:[1,0,0]
    v_fma_mix_f32 v47, v41, v56, 0 op_sel:[1,0,0] op_sel_hi:[1,0,0]
    v_fma_mix_f32 v48, v42, v56, 0 op_sel_hi:[1,0,0]
    v_fma_mix_f32 v49, v42, v56, 0 op_sel:[1,0,0] op_sel_hi:[1,0,0]
    v_fma_mix_f32 v50, v43, v56, 0 op_sel_hi:[1,0,0]
    v_fma_mix_f32 v51, v43, v56, 0 op_sel:[1,0,0] op_sel_hi:[1,0,0]
    v_fma_mix_f32 v20, v40, v20, 0 op_sel_hi:[1,0,0]
    v_fma_mix_f32 v21, v40, v21, 0 op_sel:[1,0,0] op_sel_hi:[1,0,0]
    v_fma_mix_f32 v22, v41, v22, 0 op_sel_hi:[1,0,0]
    v_fma_mix_f32 v23, v41, v23, 0 op_sel:[1,0,0] op_sel_hi:[1,0,0]
    v_fma_mix_f32 v24, v42, v24, 0 op_sel_hi:[1,0,0]
    v_fma_mix_f32 v25, v42, v25, 0 op_sel:[1,0,0] op_sel_hi:[1,0,0]
    v_fma_mix_f32 v26, v43, v26, 0 op_sel_hi:[1,0,0]
    v_fma_mix_f32 v27, v43, v27, 0 op_sel:[1,0,0] op_sel_hi:[1,0,0]
    v_pk_fma_f32 v[12:13], v[44:45], v[20:21], v[12:13]
    v_pk_fma_f32 v[14:15], v[46:47], v[22:23], v[14:15]
    v_pk_fma_f32 v[16:17], v[48:49], v[24:25], v[16:17]
    v_pk_fma_f32 v[18:19], v[50:51], v[26:27], v[18:19]
L_sent1:
    s_cmp_eq_u32 s3, 4
    s_cbranch_scc1 L_sent2
    v_mov_b32 v8, 155152
L_flS:
    s_sleep 1
    ds_read_b32 v68, v8
    s_waitcnt lgkmcnt(0)
    v_cmp_eq_u32_e64 vcc, 0, v68
    s_nop 0
    s_and_b32 s12, vcc_lo, 1
    s_cbranch_scc1 L_flS
    s_branch L_yld
L_sent2:
    s_mul_i32 s12, s6, 7
    s_lshl_b32 s12, s12, 7
    s_add_u32 s12, s12, 0x3ba000
    v_mov_b32_e64 v40, 0
L_sentl:
    buffer_load_dword v41, v40, s[60:63], s12 offen sc1
    s_add_u32 s9, s9, 1
    s_waitcnt vmcnt(0)
    v_cmp_ne_u32_e64 vcc, -1, v41
    s_cmp_gt_u32 s9, 400000
    s_cbranch_scc1 L_sentok
    s_cbranch_vccnz L_sentok
    s_sleep 2
    s_branch L_sentl
L_sentok:
    v_mov_b32 v40, 155152
    ds_write_b32 v40, v3
    buffer_load_dwordx4 v[60:63], v28, s[60:63], 0 offen sc1
    ds_read_b64_tr_b16 v[40:41], v31
    ds_read_b64_tr_b16 v[42:43], v31 offset:3840
    ds_read_b64_tr_b16 v[52:53], v31 offset:7680
    ds_read_b64_tr_b16 v[54:55], v31 offset:11520
    s_mov_b32 s14, 0xc238aa3b
    v_mul_f32 v56, 0x44800000, v32
    s_waitcnt lgkmcnt(2)
    s_nop 0
    v_and_b32 v40, 0xbff8bff8, v40
    v_and_b32 v41, 0xbff8bff8, v41
    v_and_b32 v42, 0xbff8bff8, v42
    v_and_b32 v43, 0xbff8bff8, v43
    v_fma_mix_f32 v20, v40, s14, 0 op_sel_hi:[1,0,0]
    v_fma_mix_f32 v21, v40, s14, 0 op_sel:[1,0,0] op_sel_hi:[1,0,0]
    v_fma_mix_f32 v22, v41, s14, 0 op_sel_hi:[1,0,0]
    v_fma_mix_f32 v23, v41, s14, 0 op_sel:[1,0,0] op_sel_hi:[1,0,0]
    v_fma_mix_f32 v24, v42, s14, 0 op_sel_hi:[1,0,0]
    v_fma_mix_f32 v25, v42, s14, 0 op_sel:[1,0,0] op_sel_hi:[1,0,0]
    v_fma_mix_f32 v26, v43, s14, 0 op_sel_hi:[1,0,0]
    v_fma_mix_f32 v27, v43, s14, 0 op_sel:[1,0,0] op_sel_hi:[1,0,0]
    v_exp_f32 v20, v20
    v_exp_f32 v21, v21
    v_exp_f32 v22, v22
    v_exp_f32 v23, v23
    v_exp_f32 v24, v24
    v_exp_f32 v25, v25
    v_exp_f32 v26, v26
    v_exp_f32 v27, v27
    v_pk_add_f32 v[20:21], v[20:21], 1.0 op_sel_hi:[1,0]
    v_pk_add_f32 v[22:23], v[22:23], 1.0 op_sel_hi:[1,0]
    v_pk_add_f32 v[24:25], v[24:25], 1.0 op_sel_hi:[1,0]
    v_pk_add_f32 v[26:27], v[26:27], 1.0 op_sel_hi:[1,0]
    v_rcp_f32 v20, v20
    v_rcp_f32 v21, v21
    v_rcp_f32 v22, v22
    v_rcp_f32 v23, v23
    v_rcp_f32 v24, v24
    v_rcp_f32 v25, v25
    v_rcp_f32 v26, v26
    v_rcp_f32 v27, v27
    s_waitcnt lgkmcnt(0)
    v_lshlrev_b32 v12, 16, v52
    v_and_b32 v13, 0xffff0000, v52
    v_lshlrev_b32_e64 v14, 16, v53
    v_and_b32 v15, 0xffff0000, v53
    v_lshlrev_b32_e64 v16, 16, v54
    v_and_b32 v17, 0xffff0000, v54
    v_lshlrev_b32_e64 v18, 16, v55
    v_and_b32 v19, 0xffff0000, v55
    v_fma_mix_f32 v44, v40, v56, 0 op_sel_hi:[1,0,0]
    v_fma_mix_f32 v45, v40, v56, 0 op_sel:[1,0,0] op_sel_hi:[1,0,0]
    v_fma_mix_f32 v46, v41, v56, 0 op_sel_hi:[1,0,0]
    v_fma_mix_f32 v47, v41, v56, 0 op_sel:[1,0,0] op_sel_hi:[1,0,0]
    v_fma_mix_f32 v48, v42, v56, 0 op_sel_hi:[1,0,0]
    v_fma_mix_f32 v49, v42, v56, 0 op_sel:[1,0,0] op_sel_hi:[1,0,0]
    v_fma_mix_f32 v50, v43, v56, 0 op_sel_hi:[1,0,0]
    v_fma_mix_f32 v51, v43, v56, 0 op_sel:[1,0,0] op_sel_hi:[1,0,0]
    v_fma_mix_f32 v20, v40, v20, 0 op_sel_hi:[1,0,0]
    v_fma_mix_f32 v21, v40, v21, 0 op_sel:[1,0,0] op_sel_hi:[1,0,0]
    v_fma_mix_f32 v22, v41, v22, 0 op_sel_hi:[1,0,0]
    v_fma_mix_f32 v23, v41, v23, 0 op_sel:[1,0,0] op_sel_hi:[1,0,0]
    v_fma_mix_f32 v24, v42, v24, 0 op_sel_hi:[1,0,0]
    v_fma_mix_f32 v25, v42, v25, 0 op_sel:[1,0,0] op_sel_hi:[1,0,0]
    v_fma_mix_f32 v26, v43, v26, 0 op_sel_hi:[1,0,0]
    v_fma_mix_f32 v27, v43, v27, 0 op_sel:[1,0,0] op_sel_hi:[1,0,0]
    v_pk_fma_f32 v[12:13], v[44:45], v[20:21], v[12:13]
    v_pk_fma_f32 v[14:15], v[46:47], v[22:23], v[14:15]
    v_pk_fma_f32 v[16:17], v[48:49], v[24:25], v[16:17]
    v_pk_fma_f32 v[18:19], v[50:51], v[26:27], v[18:19]
    s_branch L_yld2
    s_branch L_yld
L_ffn:
    s_mov_b64 s[80:81], s[38:39]
    s_mov_b64 s[16:17], s[40:41]
    s_mov_b64 s[20:21], s[42:43]
    s_cmp_ge_u32 s2, 252
    s_cselect_b32 s82, 0, 1605632
    s_mov_b32 s83, 0x20000
    s_mov_b64 s[18:19], s[82:83]
    s_mov_b64 s[22:23], s[82:83]
    v_lshrrev_b32 v16, 3, v1
    v_mul_u32_u24 v16, 3584, v16
    v_bfe_u32 v17, v1, 4, 1
    v_and_b32 v18, 7, v1
    v_xor_b32 v17, v17, v18
    v_lshl_add_u32 v124, v17, 4, v16
    v_xor_b32 v125, 32, v124
    v_xor_b32 v126, 64, v124
    v_xor_b32 v127, 0x60, v124
    s_mul_i32 s65, s3, 3
    s_add_u32 s65, s65, 16
    s_mov_b32 s66, 3
    s_mul_i32 s64, s65, 57344
    s_lshl_b32 s13, s6, 7
    s_add_u32 s64, s64, s13
    s_lshl_b32 s65, s65, 11
    s_mov_b32 m0, s65
    s_add_u32 s100, s64, 28672
    buffer_load_dwordx4 v124, s[80:83], s64 offen lds
    s_add_u32 m0, s65, 1024
    s_nop 0
    buffer_load_dwordx4 v125, s[80:83], s100 offen lds
    s_add_u32 m0, s65, 57344
    s_nop 0
    buffer_load_dwordx4 v126, s[16:19], s64 offen lds
    s_add_u32 m0, s65, 58368
    s_nop 0
    buffer_load_dwordx4 v127, s[16:19], s100 offen lds
    s_add_u32 s64, s64, 57344
    s_add_u32 s65, s65, 2048
    s_sub_u32 s66, s66, 1
L_fsetup:
    v_lshrrev_b32 v33, 4, v1
    v_mul_u32_u24 v33, 7168, v33
    v_and_b32 v16, 0xf0, v11
    v_add_u32 v33, v33, v16
    s_cmp_eq_u32 s3, 3
    s_cselect_b32 s13, 8, 0
    v_and_b32 v16, s13, v1
    v_lshl_or_b32 v33, v16, 28, v33
    s_mul_i32 s46, s6, 57344
    s_lshl_b32 s13, s3, 8
    s_add_u32 s46, s46, s13
    s_and_b32 s72, s68, 0x40074007
    s_and_b32 s73, s69, 0x40074007
    s_and_b32 s74, s70, 0x40074007
    s_and_b32 s75, s71, 0x40074007
    s_and_b32 s76, s68, 0xff
    s_and_b32 s77, s69, 0xff
    s_and_b32 s78, s70, 0xff
    s_and_b32 s79, s71, 0xff
    v_lshrrev_b32_e64 v4, 4, v1
    v_bfe_u32 v5, v1, 2, 2
    v_lshl_add_u32 v6, v4, 3, v5
    v_lshlrev_b32_e64 v6, 7, v6
    v_bfe_u32 v7, v1, 1, 1
    v_mov_b32 v8, 57344
    v_mad_u32_u24 v6, v7, v8, v6
    v_bfe_u32 v8, v1, 3, 2
    v_lshl_add_u32 v8, v7, 2, v8
    v_xor_b32_e64 v8, s3, v8
    v_lshl_add_u32 v6, v8, 4, v6
    v_and_b32_e64 v8, 1, v1
    v_lshl_add_u32 v6, v8, 3, v6
    v_and_b32 v7, 15, v1
    v_lshrrev_b32 v122, 3, v1
    v_bfe_u32 v5, v1, 1, 1
    v_lshl_add_u32 v122, v122, 1, v5
    v_lshl_add_u32 v122, v8, 4, v122
    v_lshlrev_b32 v122, 2, v122
    s_lshl_b32 s12, s3, 4
    s_add_u32 s12, s12, 155008
    v_lshl_add_u32 v37, v1, 1, s12
    v_mov_b32 v38, 155000
    v_cmp_gt_u32 vcc, 8, v1
    s_nop 1
    v_cndmask_b32 v37, v38, v37, vcc
    v_lshlrev_b32 v38, 4, v4
    v_add_u32 v38, 155008, v38
    v_lshrrev_b32 v5, 3, v0
    v_cmp_gt_u32 vcc, 28, v5
    v_and_b32 v39, 0x70, v11
    v_lshl_add_u32 v39, v5, 12, v39
    v_mov_b32 v5, 0x80000000
    v_cndmask_b32_e64 v39, v5, v39, vcc
    v_add_u32 v5, 121856, v11
    v_mov_b32 v123, 154952
    s_cmp_lt_u32 s3, 4
    s_cbranch_scc1 L_funit
    s_waitcnt vmcnt(5)
    ds_write_b32 v10, v3 offset:20
    s_cmp_eq_u32 s66, 0
    s_cbranch_scc1 L_fpoll
L_funit:
    s_waitcnt vmcnt(4)
    s_mov_b32 m0, s65
    s_add_u32 s100, s64, 28672
    buffer_load_dwordx4 v124, s[80:83], s64 offen lds
    s_add_u32 m0, s65, 1024
    s_nop 0
    buffer_load_dwordx4 v125, s[80:83], s100 offen lds
    s_add_u32 m0, s65, 57344
    s_nop 0
    buffer_load_dwordx4 v126, s[16:19], s64 offen lds
    s_add_u32 m0, s65, 58368
    s_nop 0
    buffer_load_dwordx4 v127, s[16:19], s100 offen lds
    s_add_u32 s64, s64, 57344
    s_add_u32 s65, s65, 2048
    s_sub_u32 s66, s66, 1
    s_cmp_lg_u32 s66, 0
    s_cbranch_scc1 L_funit
    s_cmp_eq_u32 s3, 7
    s_cbranch_scc1 L_fpoll
    s_cmp_ge_u32 s3, 4
    s_cbranch_scc1 L_fw0
    s_waitcnt vmcnt(4)
    s_add_u32 s47, s46, 0
    s_nop 0
    buffer_load_dwordx4 v[128:131], v33, s[20:23], s47 offen offset:0
    buffer_load_dwordx4 v[132:135], v33, s[20:23], s47 offen offset:896
    buffer_load_dwordx4 v[136:139], v33, s[20:23], s47 offen offset:1792
    buffer_load_dwordx4 v[140:143], v33, s[20:23], s47 offen offset:2688
    s_waitcnt vmcnt(4)
    s_nop 0
    s_add_u32 s47, s46, 3584
    buffer_load_dwordx4 v[144:147], v33, s[20:23], s47 offen offset:0
    buffer_load_dwordx4 v[148:151], v33, s[20:23], s47 offen offset:896
    buffer_load_dwordx4 v[152:155], v33, s[20:23], s47 offen offset:1792
    buffer_load_dwordx4 v[156:159], v33, s[20:23], s47 offen offset:2688
    s_waitcnt vmcnt(8)
    s_branch L_fbar
L_fpoll:
    v_mov_b32_e64 v118, s34
    global_load_dword v2, v118, s[44:45]
    s_setprio 3
    v_min_u32 v8, 13, v7
    v_lshl_add_u32 v8, v8, 2, v4
    v_lshlrev_b32 v8, 4, v8
    v_lshlrev_b32 v113, 10, v1
    s_mov_b32 s10, 0x2000
    s_mov_b32 s11, 0x20000
    s_mov_b32 s12, 0x30000
    s_mov_b32 s13, 0x40000
    s_sleep 40
    buffer_load_dwordx4 v[114:117], v11, s[60:63], s10 offen sc1
    buffer_load_dwordx4 v[118:121], v11, s[60:63], s10 offen offset:1024 sc1
L_cchk:
    s_waitcnt vmcnt(0)
    v_xor_b32 v40, s69, v115
    v_xor_b32 v41, s69, v117
    v_xor_b32 v42, s69, v119
    v_xor_b32 v43, s69, v121
    v_or3_b32 v40, v40, v41, v42
    v_or_b32 v40, v40, v43
    v_cmp_ne_u32 vcc, 0, v40
    s_add_u32 s9, s9, 1
    s_cbranch_vccz L_cok
    s_cmp_gt_u32 s9, 400000
    s_cbranch_scc1 L_cok
    s_sleep 2
    s_mov_b64 exec, vcc
    buffer_load_dwordx4 v[114:117], v11, s[60:63], s10 offen sc1
    buffer_load_dwordx4 v[118:121], v11, s[60:63], s10 offen offset:1024 sc1
    s_mov_b64 exec, -1
    s_branch L_cchk
L_cok:
    v_max3_u32 v112, v114, v116, v118
    v_max_u32_e64 v112, v112, v120
    s_nop 1
    v_max_u32_dpp v112, v112, v112 row_shr:1 row_mask:0xf bank_mask:0xf
    s_nop 1
    v_max_u32_dpp v112, v112, v112 row_shr:2 row_mask:0xf bank_mask:0xf
    s_nop 1
    v_max_u32_dpp v112, v112, v112 row_shr:4 row_mask:0xf bank_mask:0xf
    s_nop 1
    v_max_u32_dpp v112, v112, v112 row_shr:8 row_mask:0xf bank_mask:0xf
    s_nop 1
    v_max_u32_dpp v112, v112, v112 row_bcast:15 row_mask:0xa bank_mask:0xf
    s_nop 1
    v_max_u32_dpp v112, v112, v112 row_bcast:31 row_mask:0xc bank_mask:0xf
    s_nop 0
    v_readlane_b32 s8, v112, 63
    s_nop 0
    s_andn2_b32 s11, 0x7ff, s8
    s_lshr_b32 s13, s11, 5
    s_and_b32 s12, s11, 3
    s_lshl2_add_u32 s10, s13, s12
    s_lshl_b32 s12, s10, 10
    s_add_u32 s12, s12, 0x10000
    buffer_load_dwordx4 v[40:43], v8, s[60:63], s12 offen sc1
    s_lshl_b32 s13, s6, 5
    v_lshl_add_u32 v116, v7, 1, s13
    s_mul_i32 s15, s11, 896
    buffer_load_ushort v117, v116, s[52:55], s15 offen
    buffer_load_ushort v118, v116, s[56:59], 0 offen
    v_mov_b32_e64 v46, s8
    s_mov_b32 s13, 0x42000000
    s_barrier
    s_nop 0
    ds_read_b64_tr_b16 v[56:57], v6 offset:0
    ds_read_b64_tr_b16 v[58:59], v6 offset:512
    ds_read_b64_tr_b16 v[60:61], v6 offset:4096
    ds_read_b64_tr_b16 v[62:63], v6 offset:4608
    ds_read_b64_tr_b16 v[64:65], v6 offset:8192
    ds_read_b64_tr_b16 v[66:67], v6 offset:8704
    ds_read_b64_tr_b16 v[68:69], v6 offset:12288
    ds_read_b64_tr_b16 v[70:71], v6 offset:12800
    ds_read_b64_tr_b16 v[72:73], v6 offset:16384
    ds_read_b64_tr_b16 v[74:75], v6 offset:16896
    ds_read_b64_tr_b16 v[76:77], v6 offset:20480
    ds_read_b64_tr_b16 v[78:79], v6 offset:20992
    ds_read_b64_tr_b16 v[80:81], v6 offset:24576
    ds_read_b64_tr_b16 v[82:83], v6 offset:25088
    ds_read_b64_tr_b16 v[84:85], v6 offset:28672
    ds_read_b64_tr_b16 v[86:87], v6 offset:29184
    ds_read_b64_tr_b16 v[88:89], v6 offset:32768
    ds_read_b64_tr_b16 v[90:91], v6 offset:33280
    ds_read_b64_tr_b16 v[92:93], v6 offset:36864
    ds_read_b64_tr_b16 v[94:95], v6 offset:37376
    ds_read_b64_tr_b16 v[96:97], v6 offset:40960
    ds_read_b64_tr_b16 v[98:99], v6 offset:41472
    ds_read_b64_tr_b16 v[100:101], v6 offset:45056
    ds_read_b64_tr_b16 v[102:103], v6 offset:45568
    ds_read_b64_tr_b16 v[104:105], v6 offset:49152
    ds_read_b64_tr_b16 v[106:107], v6 offset:49664
    ds_read_b64_tr_b16 v[108:109], v6 offset:53248
    ds_read_b64_tr_b16 v[110:111], v6 offset:53760
    s_waitcnt vmcnt(2)
    s_cmp_lg_u32 s2, 224
    s_cbranch_scc1 L_xchk2
    v_mov_b32 v47, s69
    v_mov_b32 v48, s68
    v_mov_b32 v49, s69
    v_mov_b32 v50, s70
    v_mov_b32 v51, s71
    v_mov_b32 v52, 0
    s_mov_b32 s14, 0x1000
    s_mov_b64 exec, 1
    buffer_store_dwordx2 v[46:47], v52, s[60:63], s14 offen sc1
    buffer_store_dwordx4 v[48:51], v52, s[60:63], 0 offen sc1
    s_mov_b64 exec, -1
    s_branch L_xchk2
L_xchk:
    s_waitcnt vmcnt(0)
L_xchk2:
    v_xor_b32 v40, s72, v40
    v_xor_b32 v41, s73, v41
    v_xor_b32 v42, s74, v42
    v_xor_b32 v43, s75, v43
    v_or3_b32 v53, v40, v41, v42
    v_or_b32 v53, v53, v43
    v_and_b32 v53, v3, v53
    v_cmp_ne_u32_e64 vcc, 0, v53
    s_add_u32 s9, s9, 1
    s_cbranch_vccz L_xok
    s_cmp_gt_u32 s9, 400000
    s_cbranch_scc1 L_xok
    buffer_load_dwordx4 v[40:43], v8, s[60:63], s12 offen sc1
    s_branch L_xchk
L_xok:
    v_fma_mix_f32 v12, v40, s13, 0 op_sel_hi:[1,0,0]
    v_fma_mix_f32 v13, v40, s13, 0 op_sel:[1,0,0] op_sel_hi:[1,0,0]
    v_fma_mix_f32 v14, v41, s13, 0 op_sel_hi:[1,0,0]
    v_fma_mix_f32 v15, v41, s13, 0 op_sel:[1,0,0] op_sel_hi:[1,0,0]
    v_fma_mix_f32 v16, v42, s13, 0 op_sel_hi:[1,0,0]
    v_fma_mix_f32 v17, v42, s13, 0 op_sel:[1,0,0] op_sel_hi:[1,0,0]
    v_fma_mix_f32 v18, v43, s13, 0 op_sel_hi:[1,0,0]
    v_fma_mix_f32 v19, v43, s13, 0 op_sel:[1,0,0] op_sel_hi:[1,0,0]
    v_cvt_pk_bf16_f32 v40, v12, v13
    v_cvt_pk_bf16_f32 v41, v14, v15
    v_cvt_pk_bf16_f32 v42, v16, v17
    v_cvt_pk_bf16_f32 v43, v18, v19
    ds_write_b128 v5, v[40:43]
    ds_write_b32 v123, v46
    ds_write_b32 v123, v3 offset:208
    s_waitcnt lgkmcnt(0)
    s_branch L_fbar2
L_fw0:
    s_waitcnt vmcnt(0)
L_fbar:
    s_barrier
    s_cmp_ge_u32 s3, 4
    s_cbranch_scc1 L_nw2
    s_add_u32 s47, s46, 28672
    buffer_load_dwordx4 v[160:163], v33, s[20:23], s47 offen offset:0
    buffer_load_dwordx4 v[164:167], v33, s[20:23], s47 offen offset:896
    buffer_load_dwordx4 v[168:171], v33, s[20:23], s47 offen offset:1792
    buffer_load_dwordx4 v[172:175], v33, s[20:23], s47 offen offset:2688
    s_add_u32 s47, s46, 32256
    buffer_load_dwordx4 v[176:179], v33, s[20:23], s47 offen offset:0
    buffer_load_dwordx4 v[180:183], v33, s[20:23], s47 offen offset:896
    buffer_load_dwordx4 v[184:187], v33, s[20:23], s47 offen offset:1792
    buffer_load_dwordx4 v[188:191], v33, s[20:23], s47 offen offset:2688
L_nw2:
    ds_read_b64_tr_b16 v[56:57], v6 offset:0
    ds_read_b64_tr_b16 v[58:59], v6 offset:512
    ds_read_b64_tr_b16 v[60:61], v6 offset:4096
    ds_read_b64_tr_b16 v[62:63], v6 offset:4608
    ds_read_b64_tr_b16 v[64:65], v6 offset:8192
    ds_read_b64_tr_b16 v[66:67], v6 offset:8704
    ds_read_b64_tr_b16 v[68:69], v6 offset:12288
    ds_read_b64_tr_b16 v[70:71], v6 offset:12800
    ds_read_b64_tr_b16 v[72:73], v6 offset:16384
    ds_read_b64_tr_b16 v[74:75], v6 offset:16896
    ds_read_b64_tr_b16 v[76:77], v6 offset:20480
    ds_read_b64_tr_b16 v[78:79], v6 offset:20992
    ds_read_b64_tr_b16 v[80:81], v6 offset:24576
    ds_read_b64_tr_b16 v[82:83], v6 offset:25088
    ds_read_b64_tr_b16 v[84:85], v6 offset:28672
    ds_read_b64_tr_b16 v[86:87], v6 offset:29184
    ds_read_b64_tr_b16 v[88:89], v6 offset:32768
    ds_read_b64_tr_b16 v[90:91], v6 offset:33280
    ds_read_b64_tr_b16 v[92:93], v6 offset:36864
    ds_read_b64_tr_b16 v[94:95], v6 offset:37376
    ds_read_b64_tr_b16 v[96:97], v6 offset:40960
    ds_read_b64_tr_b16 v[98:99], v6 offset:41472
    ds_read_b64_tr_b16 v[100:101], v6 offset:45056
    ds_read_b64_tr_b16 v[102:103], v6 offset:45568
    ds_read_b64_tr_b16 v[104:105], v6 offset:49152
    ds_read_b64_tr_b16 v[106:107], v6 offset:49664
    ds_read_b64_tr_b16 v[108:109], v6 offset:53248
    ds_read_b64_tr_b16 v[110:111], v6 offset:53760
    s_cmp_ge_u32 s3, 4
    s_cbranch_scc1 L_fbar2
    s_mov_b32 s14, 0x05040100
    s_mov_b32 s15, 0x07060302
    s_waitcnt vmcnt(8)
    s_nop 0
    v_perm_b32 v192, v132, v128, s14
    v_perm_b32 v196, v132, v128, s15
    v_perm_b32 v193, v140, v136, s14
    v_perm_b32 v197, v140, v136, s15
    v_perm_b32 v194, v148, v144, s14
    v_perm_b32 v198, v148, v144, s15
    v_perm_b32 v195, v156, v152, s14
    v_perm_b32 v199, v156, v152, s15
    v_perm_b32 v200, v133, v129, s14
    v_perm_b32 v204, v133, v129, s15
    v_perm_b32 v201, v141, v137, s14
    v_perm_b32 v205, v141, v137, s15
    v_perm_b32 v202, v149, v145, s14
    v_perm_b32 v206, v149, v145, s15
    v_perm_b32 v203, v157, v153, s14
    v_perm_b32 v207, v157, v153, s15
    v_perm_b32 v208, v134, v130, s14
    v_perm_b32 v212, v134, v130, s15
    v_perm_b32 v209, v142, v138, s14
    v_perm_b32 v213, v142, v138, s15
    v_perm_b32 v210, v150, v146, s14
    v_perm_b32 v214, v150, v146, s15
    v_perm_b32 v211, v158, v154, s14
    v_perm_b32 v215, v158, v154, s15
    v_perm_b32 v216, v135, v131, s14
    v_perm_b32 v220, v135, v131, s15
    v_perm_b32 v217, v143, v139, s14
    v_perm_b32 v221, v143, v139, s15
    v_perm_b32 v218, v151, v147, s14
    v_perm_b32 v222, v151, v147, s15
    v_perm_b32 v219, v159, v155, s14
    v_perm_b32 v223, v159, v155, s15
L_fbar2:
    v_mov_b32 v44, 0
    v_mov_b32_e64 v45, 0
    s_barrier
    ds_read_b128 v[40:43], v5
    s_waitcnt lgkmcnt(0)
    s_nop 0
    v_mfma_f32_16x16x32_bf16 v[128:131], v[40:43], v[56:59], 0
    v_mfma_f32_16x16x32_bf16 v[132:135], v[40:43], v[60:63], 0
    v_mfma_f32_16x16x32_bf16 v[136:139], v[40:43], v[64:67], 0
    v_mfma_f32_16x16x32_bf16 v[140:143], v[40:43], v[68:71], 0
    v_mfma_f32_16x16x32_bf16 v[144:147], v[40:43], v[72:75], 0
    v_mfma_f32_16x16x32_bf16 v[148:151], v[40:43], v[76:79], 0
    s_nop 2
    s_nop 0
    v_add_f32_dpp v44, v128, v44 quad_perm:[0,1,2,3] row_mask:0x1 bank_mask:0xf
    v_mfma_f32_16x16x32_bf16 v[152:155], v[40:43], v[80:83], 0
    v_add_f32_dpp v45, v133, v45 quad_perm:[0,1,2,3] row_mask:0x1 bank_mask:0xf
    v_mfma_f32_16x16x32_bf16 v[156:159], v[40:43], v[84:87], 0
    v_add_f32_dpp v44, v138, v44 quad_perm:[0,1,2,3] row_mask:0x1 bank_mask:0xf
    v_mfma_f32_16x16x32_bf16 v[128:131], v[40:43], v[88:91], 0
    v_add_f32_dpp v45, v143, v45 quad_perm:[0,1,2,3] row_mask:0x1 bank_mask:0xf
    v_mfma_f32_16x16x32_bf16 v[132:135], v[40:43], v[92:95], 0
    v_add_f32_dpp v44, v144, v44 quad_perm:[0,1,2,3] row_mask:0x2 bank_mask:0xf
    v_mfma_f32_16x16x32_bf16 v[136:139], v[40:43], v[96:99], 0
    v_add_f32_dpp v45, v149, v45 quad_perm:[0,1,2,3] row_mask:0x2 bank_mask:0xf
    v_mfma_f32_16x16x32_bf16 v[140:143], v[40:43], v[100:103], 0
    v_add_f32_dpp v44, v154, v44 quad_perm:[0,1,2,3] row_mask:0x2 bank_mask:0xf
    v_mfma_f32_16x16x32_bf16 v[144:147], v[40:43], v[104:107], 0
    v_add_f32_dpp v45, v159, v45 quad_perm:[0,1,2,3] row_mask:0x2 bank_mask:0xf
    v_mfma_f32_16x16x32_bf16 v[148:151], v[40:43], v[108:111], 0
    v_add_f32_dpp v44, v128, v44 quad_perm:[0,1,2,3] row_mask:0x4 bank_mask:0xf
    v_add_f32_dpp v45, v133, v45 quad_perm:[0,1,2,3] row_mask:0x4 bank_mask:0xf
    s_nop 0
    v_add_f32_dpp v44, v138, v44 quad_perm:[0,1,2,3] row_mask:0x4 bank_mask:0xf
    v_add_f32_dpp v45, v143, v45 quad_perm:[0,1,2,3] row_mask:0x4 bank_mask:0xf
    s_nop 0
    v_add_f32_dpp v44, v144, v44 quad_perm:[0,1,2,3] row_mask:0x8 bank_mask:0xf
    s_nop 0
    v_add_f32_dpp v45, v149, v45 quad_perm:[0,1,2,3] row_mask:0x8 bank_mask:0xf
    v_add_f32 v44, v44, v45
    v_mov_b32 v45, v44
    s_nop 1
    v_permlane16_swap_b32 v44, v45
    v_add_f32 v44, v44, v45
    v_mov_b32 v45, v44
    s_nop 1
    v_permlane32_swap_b32 v44, v45
    v_add_f32 v44, v44, v45
    v_cvt_pk_bf16_f32 v44, 0, v44
    v_mul_f32 v45, 0xbfb8aa3b, v44
    v_exp_f32 v45, v45
    s_nop 0
    v_add_f32 v45, 1.0, v45
    v_rcp_f32 v45, v45
    s_nop 0
    v_mul_f32 v45, v45, v44
    v_cvt_pk_bf16_f32 v45, 0, v45
    s_nop 1
    v_mul_f32_dpp v45, v44, v45 row_ror:8 row_mask:0xf bank_mask:0xf
    v_cvt_pk_bf16_f32 v45, v45, v45
    ds_write_b16 v37, v45
    s_cmp_ge_u32 s3, 4
    s_cbranch_scc1 L_f4
    s_waitcnt vmcnt(0)
    v_perm_b32 v224, v164, v160, s14
    v_perm_b32 v228, v164, v160, s15
    v_perm_b32 v225, v172, v168, s14
    v_perm_b32 v229, v172, v168, s15
    v_perm_b32 v226, v180, v176, s14
    v_perm_b32 v230, v180, v176, s15
    v_perm_b32 v227, v188, v184, s14
    v_perm_b32 v231, v188, v184, s15
    v_perm_b32 v232, v165, v161, s14
    v_perm_b32 v236, v165, v161, s15
    v_perm_b32 v233, v173, v169, s14
    v_perm_b32 v237, v173, v169, s15
    v_perm_b32 v234, v181, v177, s14
    v_perm_b32 v238, v181, v177, s15
    v_perm_b32 v235, v189, v185, s14
    v_perm_b32 v239, v189, v185, s15
    v_perm_b32 v240, v166, v162, s14
    v_perm_b32 v244, v166, v162, s15
    v_perm_b32 v241, v174, v170, s14
    v_perm_b32 v245, v174, v170, s15
    v_perm_b32 v242, v182, v178, s14
    v_perm_b32 v246, v182, v178, s15
    v_perm_b32 v243, v190, v186, s14
    v_perm_b32 v247, v190, v186, s15
    v_perm_b32 v248, v167, v163, s14
    v_perm_b32 v252, v167, v163, s15
    v_perm_b32 v249, v175, v171, s14
    v_perm_b32 v253, v175, v171, s15
    v_perm_b32 v250, v183, v179, s14
    v_perm_b32 v254, v183, v179, s15
    v_perm_b32 v251, v191, v187, s14
    v_perm_b32 v255, v191, v187, s15
    s_waitcnt lgkmcnt(0)
    s_barrier
    ds_read_b128 v[40:43], v38
    ds_read_b128 v[44:47], v38 offset:64
    s_lshl_b32 s13, s6, 7
    s_add_u32 s13, s13, 0x210000
    v_mov_b32 v48, 0xff
    s_waitcnt lgkmcnt(1)
    v_mfma_f32_16x16x32_bf16 v[56:59], v[40:43], v[192:195], 0
    v_mfma_f32_16x16x32_bf16 v[72:75], v[40:43], v[208:211], 0
    v_mfma_f32_16x16x32_bf16 v[60:63], v[40:43], v[196:199], 0
    v_mfma_f32_16x16x32_bf16 v[76:79], v[40:43], v[212:215], 0
    s_waitcnt lgkmcnt(0)
    s_nop 0
    v_mfma_f32_16x16x32_bf16 v[56:59], v[44:47], v[224:227], v[56:59]
    v_mfma_f32_16x16x32_bf16 v[72:75], v[44:47], v[240:243], v[72:75]
    v_mfma_f32_16x16x32_bf16 v[64:67], v[40:43], v[200:203], 0
    v_mfma_f32_16x16x32_bf16 v[80:83], v[40:43], v[216:219], 0
    v_mfma_f32_16x16x32_bf16 v[60:63], v[44:47], v[228:231], v[60:63]
    v_mfma_f32_16x16x32_bf16 v[76:79], v[44:47], v[244:247], v[76:79]
    v_mfma_f32_16x16x32_bf16 v[68:71], v[40:43], v[204:207], 0
    v_mfma_f32_16x16x32_bf16 v[84:87], v[40:43], v[220:223], 0
    v_mfma_f32_16x16x32_bf16 v[64:67], v[44:47], v[232:235], v[64:67]
    v_mfma_f32_16x16x32_bf16 v[80:83], v[44:47], v[248:251], v[80:83]
    v_mfma_f32_16x16x32_bf16 v[68:71], v[44:47], v[236:239], v[68:71]
    v_mfma_f32_16x16x32_bf16 v[84:87], v[44:47], v[252:255], v[84:87]
    v_mov_b32_dpp v56, v72 quad_perm:[0,1,2,3] row_mask:0x2 bank_mask:0xf
    v_bfi_b32 v56, v48, s76, v56
    ds_bpermute_b32 v52, v122, v56
    v_mov_b32_dpp v60, v76 quad_perm:[0,1,2,3] row_mask:0x2 bank_mask:0xf
    v_bfi_b32 v60, v48, s77, v60
    ds_bpermute_b32 v53, v122, v60
    v_mov_b32_dpp v64, v80 quad_perm:[0,1,2,3] row_mask:0x2 bank_mask:0xf
    v_bfi_b32 v64, v48, s78, v64
    ds_bpermute_b32 v54, v122, v64
    v_mov_b32_dpp v68, v84 quad_perm:[0,1,2,3] row_mask:0x2 bank_mask:0xf
    v_bfi_b32 v68, v48, s79, v68
    ds_bpermute_b32 v55, v122, v68
    s_waitcnt lgkmcnt(0)
    buffer_store_dwordx4 v[52:55], v39, s[60:63], s13 offen sc1
    s_branch L_sent0
L_f4:
    s_waitcnt lgkmcnt(0)
    s_barrier
    s_cmp_lg_u32 s3, 7
    s_cbranch_scc1 L_sent0
    s_lshr_b32 s13, s11, 5
    s_and_b32 s12, s11, 3
    s_mul_i32 s10, s13, 28672
    s_lshl4_add_u32 s10, s12, s10
    v_bfe_u32 v68, v116, 4, 2
    v_lshrrev_b32 v69, 6, v116
    v_lshl_add_u32 v68, v68, 4, v69
    v_and_b32_e64 v69, 14, v116
    v_lshl_add_u32 v68, v68, 4, v69
    v_add_u32 v68, 121856, v68
    ds_read_u16 v66, v68
    v_cmp_gt_u32_e64 vcc, 16, v1
    v_mov_b32 v44, 0x80000000
    s_nop 0
    v_cndmask_b32 v64, v44, v116, vcc
    v_lshlrev_b32_e64 v44, 7, v4
    v_lshl_add_u32 v44, v7, 2, v44
    v_and_b32 v45, 3, v1
    v_lshlrev_b32 v45, 3, v45
    s_pack_ll_b32_b16 s13, s76, s78
    s_pack_ll_b32_b16 s14, s77, s79
    s_lshl_b32 s14, s14, 8
    s_or_b32 s13, s13, s14
    v_lshrrev_b32 v45, v45, s13
    v_and_b32 v45, 0xff, v45
    v_lshlrev_b32 v46, 6, v7
    s_andn2_b32 s13, 4, s11
    s_lshl_b32 s13, s13, 2
    v_mov_b32 v47, s13
    s_lshl_b32 s13, s6, 10
    s_add_u32 s10, s10, s13
    s_bfe_u32 s13, s11, 0x20003
    s_lshl2_add_u32 s10, s13, s10
    s_add_u32 s10, s10, 0x240000
    s_lshl_b32 s12, s6, 12
    s_add_u32 s12, s12, 0x210000
    s_and_b32 s13, s8, 0xffff0000
    s_not_b32 s14, s13
    s_ashr_i32 s14, s14, 31
    s_and_b32 s14, s14, 0x7fff0000
    s_or_b32 s14, s14, 0x80000000
    s_xor_b32 s13, s13, s14
    v_mov_b32 v48, 0xbfb8aa3b
    v_mul_f32 v49, s13, v48
    v_exp_f32 v49, v49
    s_mov_b64 s[64:65], s[44:45]
    v_add_f32 v49, 1.0, v49
    v_rcp_f32_e64 v49, v49
    s_mov_b64 s[66:67], s[54:55]
    v_cvt_pk_bf16_f32 v49, 0, v49
    s_waitcnt vmcnt(0) lgkmcnt(0)
    v_lshlrev_b32 v65, 16, v117
    v_lshlrev_b32 v67, 16, v118
    v_lshlrev_b32 v66, 16, v66
    v_mul_f32 v67, v67, v66
    s_sleep 12
L_pchk:
    buffer_load_dword v56, v44, s[60:63], s12 offen offset:0 sc1
    buffer_load_dword v57, v44, s[60:63], s12 offen offset:512 sc1
    buffer_load_dword v58, v44, s[60:63], s12 offen offset:1024 sc1
    buffer_load_dword v59, v44, s[60:63], s12 offen offset:1536 sc1
    buffer_load_dword v60, v44, s[60:63], s12 offen offset:2048 sc1
    buffer_load_dword v61, v44, s[60:63], s12 offen offset:2560 sc1
    buffer_load_dword v62, v44, s[60:63], s12 offen offset:3072 sc1
    buffer_load_dword v63, v46, s[60:63], s10 offen sc1
    s_add_u32 s9, s9, 1
    s_waitcnt vmcnt(1)
    v_xor_b32 v56, v56, v45
    v_xor_b32 v57, v57, v45
    v_xor_b32 v58, v58, v45
    v_xor_b32 v59, v59, v45
    v_xor_b32 v60, v60, v45
    v_xor_b32 v61, v61, v45
    v_xor_b32_e64 v62, v62, v45
    v_or3_b32 v50, v56, v57, v58
    v_or3_b32 v50, v50, v59, v60
    v_or3_b32 v50, v50, v61, v62
    v_and_b32 v50, 0xff, v50
    v_cmp_ne_u32_e64 vcc, 0, v50
    s_cmp_gt_u32 s9, 400000
    s_cbranch_scc1 L_pok
    s_cbranch_vccz L_pok
    s_sleep 2
    s_branch L_pchk
L_pok:
    v_add_f32 v56, v56, v57
    v_add_f32 v58, v58, v59
    v_add_f32 v60, v60, v61
    v_add_f32 v56, v56, v58
    v_add_f32 v60, v60, v62
    v_add_f32 v56, v56, v60
    v_mov_b32 v57, v56
    s_nop 1
    v_permlane16_swap_b32 v56, v57
    v_add_f32 v56, v56, v57
    v_mov_b32 v57, v56
    s_nop 1
    v_permlane32_swap_b32 v56, v57
    v_add_f32 v56, v56, v57
    v_cvt_pk_bf16_f32 v56, 0, v56
    v_mul_f32_e64 v56, v56, v49
    v_cvt_pk_bf16_f32 v56, 0, v56
    v_add_f32_e64 v56, v56, v66
    v_cvt_pk_bf16_f32 v56, 0, v56
    v_mul_f32 v57, v56, v48
    v_exp_f32 v57, v57
    s_nop 0
    v_add_f32 v57, 1.0, v57
    v_rcp_f32 v57, v57
    s_nop 0
    v_mul_f32 v56, v56, v57
    v_fmac_f32 v65, v67, v56
    v_mul_f32 v56, 0x3d000000, v56
L_rchk:
    s_waitcnt vmcnt(0)
    v_cmp_eq_u32 vcc, -1, v63
    s_add_u32 s9, s9, 1
    s_cbranch_vccz L_rok
    s_cmp_gt_u32 s9, 400000
    s_cbranch_scc1 L_rok
L_rw:
    s_sleep 2
    buffer_load_dword v63, v46, s[60:63], s10 offen sc1
    s_branch L_rchk
L_rok:
    v_lshlrev_b32 v63, v47, v63
    v_and_b32 v63, 0xffff0000, v63
    v_fmac_f32_e64 v65, v63, v56
    v_cvt_pk_bf16_f32 v65, v65, v65
    buffer_store_short v65, v64, s[64:67], s15 offen sc1
    s_branch L_fin
L_codeend:
.section .rodata,"a"
.p2align 6
.amdhsa_kernel recurrent_scan__ssm_conv_s4__moe_arch_mod__prompt_kernel
  .amdhsa_next_free_vgpr 256
  .amdhsa_next_free_sgpr 102
  .amdhsa_accum_offset 256
  .amdhsa_group_segment_fixed_size 0
  .amdhsa_kernarg_size 136
  .amdhsa_user_sgpr_count 2
  .amdhsa_user_sgpr_kernarg_segment_ptr 1
  .amdhsa_system_sgpr_workgroup_id_x 1
  .amdhsa_ieee_mode 0
.end_amdhsa_kernel
```
